```python
import torch

def _softmax(x, axis=-1):
    return torch.softmax(x, dim=axis)

def _gelu(x):
    return torch.nn.functional.gelu(x, approximate='tanh')

def _silu(x):
    return torch.nn.functional.silu(x)

def _sigmoid(x):
    return torch.sigmoid(x)

def _layernorm(x, axis=-1, eps=1e-05):
    m = x.mean(dim=axis, keepdim=True)
    v = x.var(dim=axis, keepdim=True, unbiased=False)
    return (x - m) / torch.sqrt(v + eps)

def _scatter_add(tgt, idx, src, axis=0):
    return tgt.clone().index_add_(axis, idx, src)

def _segment_sum(src, seg, n):
    out = torch.zeros((n,) + src.shape[1:], dtype=src.dtype)
    return out.index_add_(0, seg, src)

def _pad(x, pw):
    flat = tuple((v for pair in reversed(pw) for v in pair))
    return torch.nn.functional.pad(x, flat)
kernel_name = 'standalone__conformer_family_branchformer__speech'

def setup_inputs():

    _w = lambda a: (lambda t: t.to(torch.bfloat16) if t.is_floating_point() else t)(torch.as_tensor(a))
    B, T, D, K = (2, 4000, 144, 5)
    s = float(D) ** (-0.5)
    return {'x': _w((lambda *s: torch.randn(*s, dtype=torch.bfloat16) * 0.05)(B, T, D)), 'w_q': _w((lambda *s: torch.randn(*s, dtype=torch.bfloat16) * 1.6)(D, D) * s), 'w_k': _w((lambda *s: torch.randn(*s, dtype=torch.bfloat16) * 1.6)(D, D) * s), 'w_v': _w((lambda *s: torch.randn(*s, dtype=torch.bfloat16) * 0.4)(D, D) * s), 'w_ao': _w((lambda *s: torch.randn(*s, dtype=torch.bfloat16) * 0.4)(D, D) * s), 'w_up': _w((lambda *s: torch.randn(*s, dtype=torch.bfloat16) * 0.8)(D, 2 * D) * s), 'dw': _w((lambda *s: torch.randn(*s, dtype=torch.bfloat16) * 0.8)(K, D) * (1.0 / K)), 'w_dn': _w((lambda *s: torch.randn(*s, dtype=torch.bfloat16) * 0.4)(D, D) * s), 'w_merge': _w((lambda *s: torch.randn(*s, dtype=torch.bfloat16) * 0.4)(2 * D, D) * s)}

def reference(x, w_q, w_k, w_v, w_ao, w_up, dw, w_dn, w_merge):
    B, T, D = x.shape
    K = dw.shape[0]
    xa = _layernorm(x, axis=-1)
    q = torch.einsum('btd,de->bte', xa, w_q)
    k = torch.einsum('btd,de->bte', xa, w_k)
    v = torch.einsum('btd,de->bte', xa, w_v)
    logits = torch.einsum('btd,bsd->bts', q, k) * float(D) ** (-0.5)
    attn = _softmax(logits, axis=-1)
    ya = torch.einsum('bts,bsd->btd', attn, v)
    ya = torch.einsum('btd,de->bte', ya, w_ao)
    xc = _layernorm(x, axis=-1)
    h = _gelu(torch.einsum('btd,de->bte', xc, w_up))
    u = h[..., :D].clone()
    g = _layernorm(h[..., D:], axis=-1)
    pad = K // 2
    gp = _pad(g, ((0, 0), (pad, pad), (0, 0)))
    conv = torch.zeros_like(g)
    for i in range(K):
        conv = conv + gp[:, i:i + T, :] * dw[i][None, None, :]
    yc = torch.einsum('btd,de->bte', u * conv, w_dn)
    merged = torch.concatenate([ya, yc], axis=-1)
    out = torch.einsum('btf,fd->btd', merged, w_merge)
    return x + out
```

```asm
; @launch kernel=standalone__conformer_family_branchformer__speech_kernel grid=(256,1,1) block=(256,1,1) lds=160256
.amdgcn_target "amdgcn-amd-amdhsa--gfx950"
.text
.globl standalone__conformer_family_branchformer__speech_kernel
.p2align 8
.type standalone__conformer_family_branchformer__speech_kernel,@function
standalone__conformer_family_branchformer__speech_kernel:
    s_cmp_ge_u32 s2, 256
    s_cbranch_scc1 L1_exit
    s_load_dwordx2 s[4:5], s[0:1], 0
    s_load_dwordx2 s[6:7], s[0:1], 40
    s_load_dwordx2 s[8:9], s[0:1], 88
    s_load_dwordx2 s[10:11], s[0:1], 80
    s_memrealtime s[68:69]
    s_load_dwordx8 s[44:51], s[0:1], 8
    s_load_dwordx4 s[52:55], s[0:1], 56
    v_lshrrev_b32 v1, 6, v0
    v_and_b32 v0, 63, v0
    v_readfirstlane_b32 s28, v1
    v_and_b32 v1, 31, v0
    v_lshrrev_b32 v2, 5, v0
    v_lshlrev_b32 v8, 4, v0
    s_getpc_b64 s[36:37]
    s_lshl_b32 s3, s28, 13
    s_and_b32 s37, s37, 0xffff
    s_mov_b32 s38, L1_last - standalone__conformer_family_branchformer__speech_kernel - 128
    s_mov_b32 s39, 0x00020000
    v_lshlrev_b32 v241, 7, v0
    buffer_load_dword v240, v241, s[36:39], s3 offen
    s_cmp_ge_u32 s2, 250
    s_cbranch_scc1 L1_wt
    s_and_b32 s3, s2, 1
    s_mul_i32 s3, s3, 125
    s_lshr_b32 s29, s2, 1
    s_add_u32 s29, s29, s3
    s_mul_i32 s29, s29, 9216
    v_mul_u32_u24 v3, 288, v1
    v_lshl_add_u32 v3, v2, 4, v3
    v_add_u32 v3, 84992, v3
    s_mul_i32 s30, s28, 20480
    s_lshl_b32 s31, s28, 11
    s_add_u32 m0, s31, 84992
    s_add_u32 s31, s31, s29
    s_waitcnt lgkmcnt(0)
    s_mov_b32 s12, s4
    s_and_b32 s13, s5, 0xffff
    s_mov_b32 s14, 2304000
    s_mov_b32 s15, 0x00020000
    s_mov_b32 s64, s10
    s_and_b32 s65, s11, 0xffff
    s_mov_b32 s66, 256
    s_mov_b32 s67, 0x00020000
    s_or_b32 s68, s68, 1
    s_or_b32 s3, s2, s28
    s_cbranch_scc1 L1_np
    v_mov_b32 v242, s68
    v_mov_b32 v243, s69
    s_mov_b64 exec, 1
    buffer_store_dwordx2 v[242:243], off, s[64:67], 0 sc1
    s_mov_b64 exec, -1
L1_np:
    s_mov_b32 s16, s6
    s_and_b32 s17, s7, 0xffff
    s_mov_b32 s18, 82944
    s_mov_b32 s19, 0x00020000
    buffer_load_dwordx4 v8, s[12:15], s31 offen offset:0 lds
    buffer_load_dwordx4 v8, s[12:15], s31 offen offset:1024 lds
    buffer_load_dwordx4 v8, s[12:15], s31 offen offset:2048 lds
    s_bitcmp1_b32 s28, 0
    s_cselect_b32 s36, s46, s44
    s_cselect_b32 s37, s47, s45
    s_and_b32 s37, s37, 0xffff
    s_mov_b32 s38, 41472
    s_lshr_b32 s3, s2, 3
    s_lshr_b32 s34, s28, 1
    s_lshl1_add_u32 s3, s3, s34
    s_mul_i32 s3, s3, 768
    s_mov_b64 exec, 63
    buffer_load_dword v244, v241, s[36:39], s3 offen
    s_mov_b64 exec, -1
    s_mov_b32 m0, s30
    s_nop 0
    buffer_load_dwordx4 v8, s[16:19], s30 offen offset:0 lds
    buffer_load_dwordx4 v8, s[16:19], s30 offen offset:1024 lds
    buffer_load_dwordx4 v8, s[16:19], s30 offen offset:2048 lds
    buffer_load_dwordx4 v8, s[16:19], s30 offen offset:3072 lds
    s_add_u32 s30, s30, 4096
    s_mov_b32 m0, s30
    s_nop 0
    buffer_load_dwordx4 v8, s[16:19], s30 offen offset:0 lds
    buffer_load_dwordx4 v8, s[16:19], s30 offen offset:1024 lds
    buffer_load_dwordx4 v8, s[16:19], s30 offen offset:2048 lds
    buffer_load_dwordx4 v8, s[16:19], s30 offen offset:3072 lds
    s_add_u32 s30, s30, 4096
    s_mov_b32 m0, s30
    s_nop 0
    buffer_load_dwordx4 v8, s[16:19], s30 offen offset:0 lds
    buffer_load_dwordx4 v8, s[16:19], s30 offen offset:1024 lds
    buffer_load_dwordx4 v8, s[16:19], s30 offen offset:2048 lds
    buffer_load_dwordx4 v8, s[16:19], s30 offen offset:3072 lds
    s_mov_b32 s20, s8
    s_and_b32 s21, s9, 0xffff
    s_mov_b32 s22, 10212352
    s_mov_b32 s23, 0x00020000
    s_mov_b32 s40, 0xbdd2d3e8
    v_mov_b32 v4, s40
    v_mov_b32 v5, 0xc0135761
    v_mov_b32 v6, 1.0
    v_mov_b32 v7, 1.0
    s_mov_b32 s41, 0x3f803f80
    s_mov_b32 s44, 0x3be38e39
    s_mov_b32 s42, 0x00003f80
    s_mov_b32 s43, 0x3f800000
    s_and_b32 s31, s28, 1
    s_lshl_b32 s32, s31, 3
    v_lshlrev_b32 v9, 2, v2
    v_xor_b32 v9, v9, v1
    v_xor_b32 v9, s32, v9
    v_lshlrev_b32 v9, 4, v9
    v_lshl_add_u32 v9, v2, 9, v9
    v_bfe_u32 v10, v0, 2, 2
    v_lshl_add_u32 v10, v2, 3, v10
    v_mul_u32_u24 v10, 576, v10
    v_bfe_u32 v11, v0, 4, 1
    v_lshl_add_u32 v10, v11, 5, v10
    v_and_b32 v11, 1, v0
    v_lshl_add_u32 v10, v11, 4, v10
    v_bfe_u32 v11, v0, 1, 1
    v_lshl_add_u32 v10, v11, 3, v10
    s_lshr_b32 s33, s28, 1
    s_lshl_b32 s33, s33, 5
    s_add_u32 s33, s33, s32
    s_add_u32 s33, s33, 256
    v_add_u32 v12, s33, v10
    v_add_u32 v13, 64512, v12
    s_lshl_b32 s33, s28, 6
    v_add_u32 v10, s33, v10
    v_add_u32 v11, 64512, v10
    v_mov_b32 v14, 0
    v_mov_b32 v15, 0
    s_waitcnt vmcnt(13)
    s_barrier
    ds_read_b128 v[16:19], v3 offset:0
    ds_read_b128 v[20:23], v3 offset:32
    ds_read_b128 v[24:27], v3 offset:64
    ds_read_b128 v[28:31], v3 offset:96
    ds_read_b128 v[32:35], v3 offset:128
    ds_read_b128 v[36:39], v3 offset:160
    ds_read_b128 v[40:43], v3 offset:192
    ds_read_b128 v[44:47], v3 offset:224
    ds_read_b128 v[48:51], v3 offset:256
    s_add_u32 s30, s30, 4096
    s_mov_b32 m0, s30
    s_nop 0
    buffer_load_dwordx4 v8, s[16:19], s30 offen offset:0 lds
    s_waitcnt lgkmcnt(8)
    v_dot2_f32_bf16 v14, v16, s41, v14
    v_dot2_f32_bf16 v15, v17, s41, v15
    v_dot2_f32_bf16 v14, v18, s41, v14
    v_dot2_f32_bf16 v15, v19, s41, v15
    s_waitcnt lgkmcnt(7)
    v_dot2_f32_bf16 v14, v20, s41, v14
    v_dot2_f32_bf16 v15, v21, s41, v15
    buffer_load_dwordx4 v8, s[16:19], s30 offen offset:1024 lds
    v_dot2_f32_bf16 v14, v22, s41, v14
    v_dot2_f32_bf16 v15, v23, s41, v15
    s_waitcnt lgkmcnt(6)
    v_dot2_f32_bf16 v14, v24, s41, v14
    v_dot2_f32_bf16 v15, v25, s41, v15
    v_dot2_f32_bf16 v14, v26, s41, v14
    v_dot2_f32_bf16 v15, v27, s41, v15
    s_waitcnt lgkmcnt(5)
    buffer_load_dwordx4 v8, s[16:19], s30 offen offset:2048 lds
    v_dot2_f32_bf16 v14, v28, s41, v14
    v_dot2_f32_bf16 v15, v29, s41, v15
    v_dot2_f32_bf16 v14, v30, s41, v14
    v_dot2_f32_bf16 v15, v31, s41, v15
    s_waitcnt lgkmcnt(4)
    v_dot2_f32_bf16 v14, v32, s41, v14
    v_dot2_f32_bf16 v15, v33, s41, v15
    v_dot2_f32_bf16 v14, v34, s41, v14
    buffer_load_dwordx4 v8, s[16:19], s30 offen offset:3072 lds
    v_dot2_f32_bf16 v15, v35, s41, v15
    s_waitcnt lgkmcnt(3)
    v_dot2_f32_bf16 v14, v36, s41, v14
    v_dot2_f32_bf16 v15, v37, s41, v15
    v_dot2_f32_bf16 v14, v38, s41, v14
    v_dot2_f32_bf16 v15, v39, s41, v15
    s_waitcnt lgkmcnt(2)
    v_dot2_f32_bf16 v14, v40, s41, v14
    s_add_u32 s30, s30, 4096
    s_mov_b32 m0, s30
    s_nop 0
    buffer_load_dwordx4 v8, s[16:19], s30 offen offset:0 lds
    v_dot2_f32_bf16 v15, v41, s41, v15
    v_dot2_f32_bf16 v14, v42, s41, v14
    v_dot2_f32_bf16 v15, v43, s41, v15
    s_waitcnt lgkmcnt(1)
    v_dot2_f32_bf16 v14, v44, s41, v14
    v_dot2_f32_bf16 v15, v45, s41, v15
    v_dot2_f32_bf16 v14, v46, s41, v14
    v_dot2_f32_bf16 v15, v47, s41, v15
    buffer_load_dwordx4 v8, s[16:19], s30 offen offset:1024 lds
    s_waitcnt lgkmcnt(0)
    v_dot2_f32_bf16 v14, v48, s41, v14
    v_dot2_f32_bf16 v15, v49, s41, v15
    v_dot2_f32_bf16 v14, v50, s41, v14
    v_dot2_f32_bf16 v15, v51, s41, v15
    s_nop 2
    v_add_f32 v14, v14, v15
    v_mov_b32 v15, v14
    buffer_load_dwordx4 v8, s[16:19], s30 offen offset:2048 lds
    s_nop 1
    v_permlane32_swap_b32 v14, v15
    s_nop 1
    v_add_f32 v14, v14, v15
    v_mul_f32 v14, 0xbbe38e39, v14
    v_dot2_f32_bf16 v52, v16, s42, v14
    v_dot2_f32_bf16 v53, v16, s43, v14
    v_dot2_f32_bf16 v54, v17, s42, v14
    buffer_load_dwordx4 v8, s[16:19], s30 offen offset:3072 lds
    v_dot2_f32_bf16 v55, v17, s43, v14
    v_dot2_f32_bf16 v56, v18, s42, v14
    v_dot2_f32_bf16 v57, v18, s43, v14
    v_dot2_f32_bf16 v58, v19, s42, v14
    v_dot2_f32_bf16 v59, v19, s43, v14
    v_dot2_f32_bf16 v60, v20, s42, v14
    v_dot2_f32_bf16 v61, v20, s43, v14
    v_dot2_f32_bf16 v62, v21, s42, v14
    s_add_u32 s30, s30, 4096
    s_mov_b32 m0, s30
    s_nop 0
    buffer_load_dwordx4 v8, s[16:19], s30 offen offset:0 lds
    buffer_load_dwordx2 v[242:243], off, s[64:67], 0 sc1
    v_dot2_f32_bf16 v63, v21, s43, v14
    v_dot2_f32_bf16 v64, v22, s42, v14
    v_dot2_f32_bf16 v65, v22, s43, v14
    v_dot2_f32_bf16 v66, v23, s42, v14
    v_dot2_f32_bf16 v67, v23, s43, v14
    v_dot2_f32_bf16 v68, v24, s42, v14
    v_dot2_f32_bf16 v69, v24, s43, v14
    v_dot2_f32_bf16 v70, v25, s42, v14
    v_dot2_f32_bf16 v71, v25, s43, v14
    v_dot2_f32_bf16 v72, v26, s42, v14
    v_dot2_f32_bf16 v73, v26, s43, v14
    v_dot2_f32_bf16 v74, v27, s42, v14
    v_dot2_f32_bf16 v75, v27, s43, v14
    v_dot2_f32_bf16 v76, v28, s42, v14
    v_dot2_f32_bf16 v77, v28, s43, v14
    v_dot2_f32_bf16 v78, v29, s42, v14
    v_dot2_f32_bf16 v79, v29, s43, v14
    v_dot2_f32_bf16 v80, v30, s42, v14
    v_dot2_f32_bf16 v81, v30, s43, v14
    v_dot2_f32_bf16 v82, v31, s42, v14
    v_dot2_f32_bf16 v83, v31, s43, v14
    v_dot2_f32_bf16 v84, v32, s42, v14
    v_dot2_f32_bf16 v85, v32, s43, v14
    v_dot2_f32_bf16 v86, v33, s42, v14
    v_dot2_f32_bf16 v87, v33, s43, v14
    v_dot2_f32_bf16 v88, v34, s42, v14
    v_dot2_f32_bf16 v89, v34, s43, v14
    v_dot2_f32_bf16 v90, v35, s42, v14
    v_dot2_f32_bf16 v91, v35, s43, v14
    v_dot2_f32_bf16 v92, v36, s42, v14
    v_dot2_f32_bf16 v93, v36, s43, v14
    v_dot2_f32_bf16 v94, v37, s42, v14
    v_dot2_f32_bf16 v95, v37, s43, v14
    v_dot2_f32_bf16 v96, v38, s42, v14
    v_dot2_f32_bf16 v97, v38, s43, v14
    v_dot2_f32_bf16 v98, v39, s42, v14
    v_dot2_f32_bf16 v99, v39, s43, v14
    v_dot2_f32_bf16 v100, v40, s42, v14
    v_dot2_f32_bf16 v101, v40, s43, v14
    v_dot2_f32_bf16 v102, v41, s42, v14
    v_dot2_f32_bf16 v103, v41, s43, v14
    v_dot2_f32_bf16 v104, v42, s42, v14
    v_dot2_f32_bf16 v105, v42, s43, v14
    v_dot2_f32_bf16 v106, v43, s42, v14
    v_dot2_f32_bf16 v107, v43, s43, v14
    v_dot2_f32_bf16 v108, v44, s42, v14
    v_dot2_f32_bf16 v109, v44, s43, v14
    v_dot2_f32_bf16 v110, v45, s42, v14
    v_dot2_f32_bf16 v111, v45, s43, v14
    v_dot2_f32_bf16 v112, v46, s42, v14
    v_dot2_f32_bf16 v113, v46, s43, v14
    v_dot2_f32_bf16 v114, v47, s42, v14
    v_dot2_f32_bf16 v115, v47, s43, v14
    v_dot2_f32_bf16 v116, v48, s42, v14
    v_dot2_f32_bf16 v117, v48, s43, v14
    v_dot2_f32_bf16 v118, v49, s42, v14
    v_dot2_f32_bf16 v119, v49, s43, v14
    v_dot2_f32_bf16 v120, v50, s42, v14
    v_dot2_f32_bf16 v121, v50, s43, v14
    v_dot2_f32_bf16 v122, v51, s42, v14
    v_dot2_f32_bf16 v123, v51, s43, v14
    s_nop 2
    v_pk_mul_f32 v[124:125], v[52:53], v[52:53]
    v_pk_mul_f32 v[126:127], v[54:55], v[54:55]
    v_pk_fma_f32 v[124:125], v[56:57], v[56:57], v[124:125]
    v_pk_fma_f32 v[126:127], v[58:59], v[58:59], v[126:127]
    v_pk_fma_f32 v[124:125], v[60:61], v[60:61], v[124:125]
    v_pk_fma_f32 v[126:127], v[62:63], v[62:63], v[126:127]
    v_pk_fma_f32 v[124:125], v[64:65], v[64:65], v[124:125]
    v_pk_fma_f32 v[126:127], v[66:67], v[66:67], v[126:127]
    v_pk_fma_f32 v[124:125], v[68:69], v[68:69], v[124:125]
    v_pk_fma_f32 v[126:127], v[70:71], v[70:71], v[126:127]
    v_pk_fma_f32 v[124:125], v[72:73], v[72:73], v[124:125]
    v_pk_fma_f32 v[126:127], v[74:75], v[74:75], v[126:127]
    v_pk_fma_f32 v[124:125], v[76:77], v[76:77], v[124:125]
    v_pk_fma_f32 v[126:127], v[78:79], v[78:79], v[126:127]
    v_pk_fma_f32 v[124:125], v[80:81], v[80:81], v[124:125]
    v_pk_fma_f32 v[126:127], v[82:83], v[82:83], v[126:127]
    v_pk_fma_f32 v[124:125], v[84:85], v[84:85], v[124:125]
    v_pk_fma_f32 v[126:127], v[86:87], v[86:87], v[126:127]
    v_pk_fma_f32 v[124:125], v[88:89], v[88:89], v[124:125]
    v_pk_fma_f32 v[126:127], v[90:91], v[90:91], v[126:127]
    v_pk_fma_f32 v[124:125], v[92:93], v[92:93], v[124:125]
    v_pk_fma_f32 v[126:127], v[94:95], v[94:95], v[126:127]
    v_pk_fma_f32 v[124:125], v[96:97], v[96:97], v[124:125]
    v_pk_fma_f32 v[126:127], v[98:99], v[98:99], v[126:127]
    v_pk_fma_f32 v[124:125], v[100:101], v[100:101], v[124:125]
    v_pk_fma_f32 v[126:127], v[102:103], v[102:103], v[126:127]
    v_pk_fma_f32 v[124:125], v[104:105], v[104:105], v[124:125]
    v_pk_fma_f32 v[126:127], v[106:107], v[106:107], v[126:127]
    v_pk_fma_f32 v[124:125], v[108:109], v[108:109], v[124:125]
    v_pk_fma_f32 v[126:127], v[110:111], v[110:111], v[126:127]
    v_pk_fma_f32 v[124:125], v[112:113], v[112:113], v[124:125]
    v_pk_fma_f32 v[126:127], v[114:115], v[114:115], v[126:127]
    v_pk_fma_f32 v[124:125], v[116:117], v[116:117], v[124:125]
    v_pk_fma_f32 v[126:127], v[118:119], v[118:119], v[126:127]
    v_pk_fma_f32 v[124:125], v[120:121], v[120:121], v[124:125]
    v_pk_fma_f32 v[126:127], v[122:123], v[122:123], v[126:127]
    v_pk_add_f32 v[124:125], v[124:125], v[126:127]
    s_nop 0
    v_add_f32 v14, v124, v125
    v_mov_b32 v15, v14
    s_nop 1
    v_permlane32_swap_b32 v14, v15
    s_nop 1
    v_add_f32 v14, v14, v15
    v_mov_b32 v15, 0x3727c5ac
    v_fmac_f32 v15, 0x3be38e39, v14
    v_rsq_f32 v14, v15
    s_nop 0
    v_pk_mul_f32 v[52:53], v[52:53], v[14:15] op_sel_hi:[1,0]
    v_pk_mul_f32 v[54:55], v[54:55], v[14:15] op_sel_hi:[1,0]
    v_pk_mul_f32 v[56:57], v[56:57], v[14:15] op_sel_hi:[1,0]
    v_pk_mul_f32 v[58:59], v[58:59], v[14:15] op_sel_hi:[1,0]
    v_pk_mul_f32 v[60:61], v[60:61], v[14:15] op_sel_hi:[1,0]
    v_pk_mul_f32 v[62:63], v[62:63], v[14:15] op_sel_hi:[1,0]
    v_pk_mul_f32 v[64:65], v[64:65], v[14:15] op_sel_hi:[1,0]
    v_pk_mul_f32 v[66:67], v[66:67], v[14:15] op_sel_hi:[1,0]
    v_pk_mul_f32 v[68:69], v[68:69], v[14:15] op_sel_hi:[1,0]
    v_pk_mul_f32 v[70:71], v[70:71], v[14:15] op_sel_hi:[1,0]
    v_pk_mul_f32 v[72:73], v[72:73], v[14:15] op_sel_hi:[1,0]
    v_pk_mul_f32 v[74:75], v[74:75], v[14:15] op_sel_hi:[1,0]
    v_pk_mul_f32 v[76:77], v[76:77], v[14:15] op_sel_hi:[1,0]
    v_pk_mul_f32 v[78:79], v[78:79], v[14:15] op_sel_hi:[1,0]
    v_pk_mul_f32 v[80:81], v[80:81], v[14:15] op_sel_hi:[1,0]
    v_pk_mul_f32 v[82:83], v[82:83], v[14:15] op_sel_hi:[1,0]
    v_pk_mul_f32 v[84:85], v[84:85], v[14:15] op_sel_hi:[1,0]
    v_pk_mul_f32 v[86:87], v[86:87], v[14:15] op_sel_hi:[1,0]
    v_pk_mul_f32 v[88:89], v[88:89], v[14:15] op_sel_hi:[1,0]
    v_pk_mul_f32 v[90:91], v[90:91], v[14:15] op_sel_hi:[1,0]
    v_pk_mul_f32 v[92:93], v[92:93], v[14:15] op_sel_hi:[1,0]
    v_pk_mul_f32 v[94:95], v[94:95], v[14:15] op_sel_hi:[1,0]
    v_pk_mul_f32 v[96:97], v[96:97], v[14:15] op_sel_hi:[1,0]
    v_pk_mul_f32 v[98:99], v[98:99], v[14:15] op_sel_hi:[1,0]
    v_pk_mul_f32 v[100:101], v[100:101], v[14:15] op_sel_hi:[1,0]
    v_pk_mul_f32 v[102:103], v[102:103], v[14:15] op_sel_hi:[1,0]
    v_pk_mul_f32 v[104:105], v[104:105], v[14:15] op_sel_hi:[1,0]
    v_pk_mul_f32 v[106:107], v[106:107], v[14:15] op_sel_hi:[1,0]
    v_pk_mul_f32 v[108:109], v[108:109], v[14:15] op_sel_hi:[1,0]
    v_pk_mul_f32 v[110:111], v[110:111], v[14:15] op_sel_hi:[1,0]
    v_pk_mul_f32 v[112:113], v[112:113], v[14:15] op_sel_hi:[1,0]
    v_pk_mul_f32 v[114:115], v[114:115], v[14:15] op_sel_hi:[1,0]
    v_pk_mul_f32 v[116:117], v[116:117], v[14:15] op_sel_hi:[1,0]
    v_pk_mul_f32 v[118:119], v[118:119], v[14:15] op_sel_hi:[1,0]
    v_pk_mul_f32 v[120:121], v[120:121], v[14:15] op_sel_hi:[1,0]
    v_pk_mul_f32 v[122:123], v[122:123], v[14:15] op_sel_hi:[1,0]
    v_cvt_pk_bf16_f32 v16, v52, v53
    v_cvt_pk_bf16_f32 v17, v54, v55
    v_cvt_pk_bf16_f32 v18, v56, v57
    v_cvt_pk_bf16_f32 v19, v58, v59
    v_cvt_pk_bf16_f32 v20, v60, v61
    v_cvt_pk_bf16_f32 v21, v62, v63
    v_cvt_pk_bf16_f32 v22, v64, v65
    v_cvt_pk_bf16_f32 v23, v66, v67
    v_cvt_pk_bf16_f32 v24, v68, v69
    v_cvt_pk_bf16_f32 v25, v70, v71
    v_cvt_pk_bf16_f32 v26, v72, v73
    v_cvt_pk_bf16_f32 v27, v74, v75
    v_cvt_pk_bf16_f32 v28, v76, v77
    v_cvt_pk_bf16_f32 v29, v78, v79
    v_cvt_pk_bf16_f32 v30, v80, v81
    v_cvt_pk_bf16_f32 v31, v82, v83
    v_cvt_pk_bf16_f32 v32, v84, v85
    v_cvt_pk_bf16_f32 v33, v86, v87
    v_cvt_pk_bf16_f32 v34, v88, v89
    v_cvt_pk_bf16_f32 v35, v90, v91
    v_cvt_pk_bf16_f32 v36, v92, v93
    v_cvt_pk_bf16_f32 v37, v94, v95
    v_cvt_pk_bf16_f32 v38, v96, v97
    v_cvt_pk_bf16_f32 v39, v98, v99
    v_cvt_pk_bf16_f32 v40, v100, v101
    v_cvt_pk_bf16_f32 v41, v102, v103
    v_cvt_pk_bf16_f32 v42, v104, v105
    v_cvt_pk_bf16_f32 v43, v106, v107
    v_cvt_pk_bf16_f32 v44, v108, v109
    v_cvt_pk_bf16_f32 v45, v110, v111
    v_cvt_pk_bf16_f32 v46, v112, v113
    v_cvt_pk_bf16_f32 v47, v114, v115
    v_cvt_pk_bf16_f32 v48, v116, v117
    v_cvt_pk_bf16_f32 v49, v118, v119
    v_cvt_pk_bf16_f32 v50, v120, v121
    v_cvt_pk_bf16_f32 v51, v122, v123
    v_xor_b32 v3, 0x80, v9
    s_cmp_eq_u32 s28, 0
    s_cbranch_scc0 L1_std
    s_add_u32 s34, s29, 4096
    s_add_u32 s35, s29, 8192
    buffer_store_dwordx4 v[16:19], v9, s[20:23], s29 offen offset:0 sc1
    buffer_store_dwordx4 v[20:23], v3, s[20:23], s29 offen offset:1024 sc1
    buffer_store_dwordx4 v[24:27], v9, s[20:23], s29 offen offset:2048 sc1
    buffer_store_dwordx4 v[28:31], v3, s[20:23], s29 offen offset:3072 sc1
    buffer_store_dwordx4 v[32:35], v9, s[20:23], s34 offen offset:0 sc1
    buffer_store_dwordx4 v[36:39], v3, s[20:23], s34 offen offset:1024 sc1
    buffer_store_dwordx4 v[40:43], v9, s[20:23], s34 offen offset:2048 sc1
    buffer_store_dwordx4 v[44:47], v3, s[20:23], s34 offen offset:3072 sc1
    buffer_store_dwordx4 v[48:51], v9, s[20:23], s35 offen offset:0 sc1
    s_waitcnt vmcnt(9)
    s_branch L1_nq2
L1_std:
    s_cmp_eq_u32 s28, 1
    s_cbranch_scc0 L1_nq
    v_add_u32 v3, 119808, v3
    v_add_u32 v9, 119808, v9
    ds_write_b128 v3, v[16:19] offset:0
    ds_write_b128 v9, v[20:23] offset:1024
    ds_write_b128 v3, v[24:27] offset:2048
    ds_write_b128 v9, v[28:31] offset:3072
    ds_write_b128 v3, v[32:35] offset:4096
    ds_write_b128 v9, v[36:39] offset:5120
    ds_write_b128 v3, v[40:43] offset:6144
    ds_write_b128 v9, v[44:47] offset:7168
    ds_write_b128 v3, v[48:51] offset:8192
L1_nq:
    s_waitcnt vmcnt(0)
L1_nq2:
    s_mov_b32 s3, 0x4000
L1_tkm:
    v_readfirstlane_b32 s68, v242
    v_readfirstlane_b32 s69, v243
    s_cmp_lg_u32 s68, 0
    s_cbranch_scc1 L1_tkdm
    s_sub_u32 s3, s3, 1
    s_cbranch_scc1 L1_tkdm
    buffer_load_dwordx2 v[242:243], off, s[64:67], 0 sc1
    s_waitcnt vmcnt(0)
    s_branch L1_tkm
L1_tkdm:
    s_lshl_b32 s63, s2, 8
    s_add_u32 s63, s63, 10146816
    s_barrier
    ds_read_b64_tr_b16 v[124:125], v10 offset:320
    ds_read_b64_tr_b16 v[126:127], v10 offset:2624
    ds_read_b64_tr_b16 v[128:129], v10 offset:9536
    ds_read_b64_tr_b16 v[130:131], v10 offset:11840
    ds_read_b64_tr_b16 v[132:133], v10 offset:18752
    ds_read_b64_tr_b16 v[134:135], v10 offset:21056
    ds_read_b64_tr_b16 v[136:137], v10 offset:27968
    ds_read_b64_tr_b16 v[138:139], v10 offset:30272
    ds_read_b64_tr_b16 v[140:141], v10 offset:37184
    ds_read_b64_tr_b16 v[142:143], v10 offset:39488
    ds_read_b64_tr_b16 v[144:145], v10 offset:46400
    ds_read_b64_tr_b16 v[146:147], v10 offset:48704
    ds_read_b64_tr_b16 v[148:149], v10 offset:55616
    ds_read_b64_tr_b16 v[150:151], v10 offset:57920
    s_waitcnt lgkmcnt(12)
    v_mfma_f32_32x32x16_bf16 v[52:67], v[124:127], v[16:19], 0
    ds_read_b64_tr_b16 v[152:153], v11 offset:320
    ds_read_b64_tr_b16 v[154:155], v11 offset:2624
    s_waitcnt lgkmcnt(12)
    v_mfma_f32_32x32x16_bf16 v[52:67], v[128:131], v[20:23], v[52:67]
    ds_read_b64_tr_b16 v[156:157], v11 offset:9536
    ds_read_b64_tr_b16 v[158:159], v11 offset:11840
    s_waitcnt lgkmcnt(12)
    v_mfma_f32_32x32x16_bf16 v[52:67], v[132:135], v[24:27], v[52:67]
    ds_read_b64_tr_b16 v[160:161], v12 offset:0
    ds_read_b64_tr_b16 v[162:163], v12 offset:2304
    s_waitcnt lgkmcnt(12)
    v_mfma_f32_32x32x16_bf16 v[52:67], v[136:139], v[28:31], v[52:67]
    ds_read_b64_tr_b16 v[164:165], v12 offset:9216
    ds_read_b64_tr_b16 v[166:167], v12 offset:11520
    s_waitcnt lgkmcnt(12)
    v_mfma_f32_32x32x16_bf16 v[52:67], v[140:143], v[32:35], v[52:67]
    ds_read_b64_tr_b16 v[168:169], v12 offset:18432
    ds_read_b64_tr_b16 v[170:171], v12 offset:20736
    s_waitcnt lgkmcnt(12)
    v_mfma_f32_32x32x16_bf16 v[52:67], v[144:147], v[36:39], v[52:67]
    ds_read_b64_tr_b16 v[172:173], v12 offset:27648
    ds_read_b64_tr_b16 v[174:175], v12 offset:29952
    s_waitcnt lgkmcnt(12)
    v_mfma_f32_32x32x16_bf16 v[52:67], v[148:151], v[40:43], v[52:67]
    ds_read_b64_tr_b16 v[176:177], v12 offset:36864
    ds_read_b64_tr_b16 v[178:179], v12 offset:39168
    s_waitcnt lgkmcnt(12)
    v_mfma_f32_32x32x16_bf16 v[52:67], v[152:155], v[44:47], v[52:67]
    ds_read_b64_tr_b16 v[180:181], v12 offset:46080
    ds_read_b64_tr_b16 v[182:183], v12 offset:48384
    s_waitcnt lgkmcnt(12)
    v_mfma_f32_32x32x16_bf16 v[52:67], v[156:159], v[48:51], v[52:67]
    ds_read_b64_tr_b16 v[184:185], v12 offset:55296
    ds_read_b64_tr_b16 v[186:187], v12 offset:57600
    s_waitcnt lgkmcnt(12)
    v_mfma_f32_32x32x16_bf16 v[68:83], v[160:163], v[16:19], 0
    ds_read_b64_tr_b16 v[188:189], v13 offset:0
    ds_read_b64_tr_b16 v[190:191], v13 offset:2304
    s_waitcnt lgkmcnt(12)
    v_mfma_f32_32x32x16_bf16 v[68:83], v[164:167], v[20:23], v[68:83]
    ds_read_b64_tr_b16 v[192:193], v13 offset:9216
    ds_read_b64_tr_b16 v[194:195], v13 offset:11520
    s_waitcnt lgkmcnt(12)
    v_mfma_f32_32x32x16_bf16 v[68:83], v[168:171], v[24:27], v[68:83]
    ds_read_b64_tr_b16 v[196:197], v10 offset:0
    ds_read_b64_tr_b16 v[198:199], v10 offset:2304
    v_mul_f32 v100, v52, v52
    v_mul_f32 v101, v53, v53
    v_mul_f32 v102, v54, v54
    v_mul_f32 v103, v55, v55
    v_fma_f32 v100, v100, s40, v5
    v_fma_f32 v101, v101, s40, v5
    v_fma_f32 v102, v102, s40, v5
    s_waitcnt lgkmcnt(12)
    v_mfma_f32_32x32x16_bf16 v[68:83], v[172:175], v[28:31], v[68:83]
    ds_read_b64_tr_b16 v[200:201], v10 offset:9216
    ds_read_b64_tr_b16 v[202:203], v10 offset:11520
    s_cmp_eq_u32 s28, 0
    s_cbranch_scc0 L1_nofl
    s_waitcnt vmcnt(0)
    v_mov_b32 v242, s68
    v_mov_b32 v243, s69
    s_mov_b64 exec, 1
    buffer_store_dwordx2 v[242:243], off, s[20:23], s63 sc1
    s_mov_b64 exec, -1
L1_nofl:
    v_fma_f32 v103, v103, s40, v5
    v_mul_f32 v100, v100, v52
    v_mul_f32 v101, v101, v53
    v_mul_f32 v102, v102, v54
    v_mul_f32 v103, v103, v55
    v_exp_f32 v100, v100
    v_exp_f32 v101, v101
    s_waitcnt lgkmcnt(12)
    v_mfma_f32_32x32x16_bf16 v[68:83], v[176:179], v[32:35], v[68:83]
    ds_read_b64_tr_b16 v[204:205], v10 offset:18432
    ds_read_b64_tr_b16 v[206:207], v10 offset:20736
    v_exp_f32 v102, v102
    v_exp_f32 v103, v103
    v_add_f32 v100, 1.0, v100
    v_add_f32 v101, 1.0, v101
    v_add_f32 v102, 1.0, v102
    v_add_f32 v103, 1.0, v103
    v_rcp_f32 v100, v100
    s_waitcnt lgkmcnt(12)
    v_mfma_f32_32x32x16_bf16 v[68:83], v[180:183], v[36:39], v[68:83]
    ds_read_b64_tr_b16 v[208:209], v10 offset:27648
    ds_read_b64_tr_b16 v[210:211], v10 offset:29952
    v_rcp_f32 v101, v101
    v_rcp_f32 v102, v102
    v_rcp_f32 v103, v103
    v_mul_f32 v52, v52, v100
    v_mul_f32 v53, v53, v101
    v_mul_f32 v54, v54, v102
    v_mul_f32 v55, v55, v103
    s_waitcnt lgkmcnt(12)
    v_mfma_f32_32x32x16_bf16 v[68:83], v[184:187], v[40:43], v[68:83]
    ds_read_b64_tr_b16 v[212:213], v10 offset:36864
    ds_read_b64_tr_b16 v[214:215], v10 offset:39168
    v_mul_f32 v104, v56, v56
    v_mul_f32 v105, v57, v57
    v_mul_f32 v106, v58, v58
    v_mul_f32 v107, v59, v59
    v_fma_f32 v104, v104, s40, v5
    v_fma_f32 v105, v105, s40, v5
    v_fma_f32 v106, v106, s40, v5
    s_waitcnt lgkmcnt(12)
    v_mfma_f32_32x32x16_bf16 v[68:83], v[188:191], v[44:47], v[68:83]
    ds_read_b64_tr_b16 v[216:217], v10 offset:46080
    ds_read_b64_tr_b16 v[218:219], v10 offset:48384
    v_fma_f32 v107, v107, s40, v5
    v_mul_f32 v104, v104, v56
    v_mul_f32 v105, v105, v57
    v_mul_f32 v106, v106, v58
    v_mul_f32 v107, v107, v59
    v_exp_f32 v104, v104
    v_exp_f32 v105, v105
    s_waitcnt lgkmcnt(12)
    v_mfma_f32_32x32x16_bf16 v[68:83], v[192:195], v[48:51], v[68:83]
    ds_read_b64_tr_b16 v[220:221], v10 offset:55296
    ds_read_b64_tr_b16 v[222:223], v10 offset:57600
    v_exp_f32 v106, v106
    v_exp_f32 v107, v107
    v_add_f32 v104, 1.0, v104
    v_add_f32 v105, 1.0, v105
    v_add_f32 v106, 1.0, v106
    v_add_f32 v107, 1.0, v107
    v_rcp_f32 v104, v104
    s_waitcnt lgkmcnt(12)
    v_mfma_f32_32x32x16_bf16 v[84:99], v[196:199], v[16:19], 0
    ds_read_b64_tr_b16 v[224:225], v11 offset:0
    ds_read_b64_tr_b16 v[226:227], v11 offset:2304
    v_rcp_f32 v105, v105
    v_rcp_f32 v106, v106
    v_rcp_f32 v107, v107
    v_mul_f32 v56, v56, v104
    v_mul_f32 v57, v57, v105
    v_mul_f32 v58, v58, v106
    v_mul_f32 v59, v59, v107
    s_waitcnt lgkmcnt(12)
    v_mfma_f32_32x32x16_bf16 v[84:99], v[200:203], v[20:23], v[84:99]
    ds_read_b64_tr_b16 v[228:229], v11 offset:9216
    ds_read_b64_tr_b16 v[230:231], v11 offset:11520
    v_mul_f32 v108, v60, v60
    v_mul_f32 v109, v61, v61
    v_mul_f32 v110, v62, v62
    v_mul_f32 v111, v63, v63
    v_fma_f32 v108, v108, s40, v5
    v_fma_f32 v109, v109, s40, v5
    v_fma_f32 v110, v110, s40, v5
    s_waitcnt lgkmcnt(12)
    v_mfma_f32_32x32x16_bf16 v[84:99], v[204:207], v[24:27], v[84:99]
    v_fma_f32 v111, v111, s40, v5
    v_mul_f32 v108, v108, v60
    v_mul_f32 v109, v109, v61
    v_mul_f32 v110, v110, v62
    v_mul_f32 v111, v111, v63
    v_exp_f32 v108, v108
    v_exp_f32 v109, v109
    s_waitcnt lgkmcnt(10)
    v_mfma_f32_32x32x16_bf16 v[84:99], v[208:211], v[28:31], v[84:99]
    v_exp_f32 v110, v110
    v_exp_f32 v111, v111
    v_add_f32 v108, 1.0, v108
    v_add_f32 v109, 1.0, v109
    v_add_f32 v110, 1.0, v110
    v_add_f32 v111, 1.0, v111
    v_rcp_f32 v108, v108
    s_waitcnt lgkmcnt(8)
    v_mfma_f32_32x32x16_bf16 v[84:99], v[212:215], v[32:35], v[84:99]
    v_rcp_f32 v109, v109
    v_rcp_f32 v110, v110
    v_rcp_f32 v111, v111
    v_mul_f32 v60, v60, v108
    v_mul_f32 v61, v61, v109
    v_mul_f32 v62, v62, v110
    v_mul_f32 v63, v63, v111
    s_waitcnt lgkmcnt(6)
    v_mfma_f32_32x32x16_bf16 v[84:99], v[216:219], v[36:39], v[84:99]
    v_mul_f32 v112, v64, v64
    v_mul_f32 v113, v65, v65
    v_mul_f32 v114, v66, v66
    v_mul_f32 v115, v67, v67
    v_fma_f32 v112, v112, s40, v5
    v_fma_f32 v113, v113, s40, v5
    v_fma_f32 v114, v114, s40, v5
    s_waitcnt lgkmcnt(4)
    v_mfma_f32_32x32x16_bf16 v[84:99], v[220:223], v[40:43], v[84:99]
    v_fma_f32 v115, v115, s40, v5
    v_mul_f32 v112, v112, v64
    v_mul_f32 v113, v113, v65
    v_mul_f32 v114, v114, v66
    v_mul_f32 v115, v115, v67
    v_exp_f32 v112, v112
    v_exp_f32 v113, v113
    s_waitcnt lgkmcnt(2)
    v_mfma_f32_32x32x16_bf16 v[84:99], v[224:227], v[44:47], v[84:99]
    v_exp_f32 v114, v114
    v_exp_f32 v115, v115
    v_add_f32 v112, 1.0, v112
    v_add_f32 v113, 1.0, v113
    v_add_f32 v114, 1.0, v114
    v_add_f32 v115, 1.0, v115
    v_rcp_f32 v112, v112
    s_waitcnt lgkmcnt(0)
    v_mfma_f32_32x32x16_bf16 v[84:99], v[228:231], v[48:51], v[84:99]
    v_rcp_f32 v113, v113
    v_rcp_f32 v114, v114
    v_rcp_f32 v115, v115
    v_mul_f32 v64, v64, v112
    v_mul_f32 v65, v65, v113
    v_mul_f32 v66, v66, v114
    v_mul_f32 v67, v67, v115
    v_mul_f32 v100, v68, v68
    v_mul_f32 v101, v69, v69
    v_mul_f32 v102, v70, v70
    v_mul_f32 v103, v71, v71
    v_fma_f32 v100, v100, s40, v5
    v_fma_f32 v101, v101, s40, v5
    v_fma_f32 v102, v102, s40, v5
    v_fma_f32 v103, v103, s40, v5
    v_mul_f32 v100, v100, v68
    v_mul_f32 v101, v101, v69
    v_mul_f32 v102, v102, v70
    v_mul_f32 v103, v103, v71
    v_exp_f32 v100, v100
    v_exp_f32 v101, v101
    v_exp_f32 v102, v102
    v_exp_f32 v103, v103
    v_add_f32 v100, 1.0, v100
    v_add_f32 v101, 1.0, v101
    v_add_f32 v102, 1.0, v102
    v_add_f32 v103, 1.0, v103
    v_rcp_f32 v100, v100
    v_rcp_f32 v101, v101
    v_rcp_f32 v102, v102
    v_rcp_f32 v103, v103
    v_mul_f32 v68, v68, v100
    v_mul_f32 v69, v69, v101
    v_mul_f32 v70, v70, v102
    v_mul_f32 v71, v71, v103
    s_cmp_ge_u32 s28, 2
    s_cselect_b32 s35, 1.0, 0
    v_pk_add_f32 v[100:101], v[68:69], v[70:71]
    v_pk_mul_f32 v[102:103], v[68:69], v[68:69]
    v_pk_fma_f32 v[102:103], v[70:71], v[70:71], v[102:103]
    v_mul_f32 v100, s35, v100
    v_mul_f32 v101, s35, v101
    v_mul_f32 v102, s35, v102
    v_mul_f32 v103, s35, v103
    v_pk_add_f32 v[100:101], v[100:101], v[52:53]
    v_pk_fma_f32 v[102:103], v[52:53], v[52:53], v[102:103]
    v_pk_add_f32 v[100:101], v[100:101], v[54:55]
    v_pk_fma_f32 v[102:103], v[54:55], v[54:55], v[102:103]
    v_pk_add_f32 v[100:101], v[100:101], v[56:57]
    v_pk_fma_f32 v[102:103], v[56:57], v[56:57], v[102:103]
    v_pk_add_f32 v[100:101], v[100:101], v[58:59]
    v_pk_fma_f32 v[102:103], v[58:59], v[58:59], v[102:103]
    v_pk_add_f32 v[100:101], v[100:101], v[60:61]
    v_pk_fma_f32 v[102:103], v[60:61], v[60:61], v[102:103]
    v_pk_add_f32 v[100:101], v[100:101], v[62:63]
    v_pk_fma_f32 v[102:103], v[62:63], v[62:63], v[102:103]
    v_pk_add_f32 v[100:101], v[100:101], v[64:65]
    v_pk_fma_f32 v[102:103], v[64:65], v[64:65], v[102:103]
    v_pk_add_f32 v[100:101], v[100:101], v[66:67]
    v_pk_fma_f32 v[102:103], v[66:67], v[66:67], v[102:103]
    v_lshlrev_b32 v14, 6, v1
    v_add_u32 v14, 147968, v14
    s_lshl_b32 s36, s28, 4
    v_lshl_add_u32 v15, v2, 3, s36
    v_add_u32 v15, v15, v14
    v_add_f32 v100, v100, v101
    v_add_f32 v101, v102, v103
    ds_write_b64 v15, v[100:101]
    s_and_b32 s3, s2, 1
    s_bfe_u32 s52, s2, 0x10001
    s_mul_i32 s57, s52, 63
    s_add_u32 s57, s57, s28
    v_lshl_add_u32 v18, v0, 2, s57
    v_min_u32 v18, 124, v18
    v_lshl_add_u32 v18, v18, 1, s3
    v_add_u32 v19, 232, v0
    v_min_u32 v19, 252, v19
    v_cmp_gt_u32 vcc, 16, v0
    s_xor_b32 s57, s2, 2
    s_mov_b32 s12, s8
    s_and_b32 s13, s9, 0xffff
    s_mov_b32 s14, 10212352
    s_mov_b32 s15, 0x00020000
    s_mov_b32 s60, 10146816
    v_cndmask_b32 v18, v19, v18, vcc
    v_writelane_b32 v18, s57, 16
    v_writelane_b32 v18, s2, 17
    v_lshlrev_b32 v18, 8, v18
    buffer_load_dwordx2 v[22:23], v18, s[12:15], s60 offen sc1
    v_pk_mul_f32 v[104:105], v[84:85], v[84:85]
    v_pk_mul_f32 v[106:107], v[86:87], v[86:87]
    v_pk_mul_f32 v[108:109], v[88:89], v[88:89]
    v_pk_mul_f32 v[110:111], v[90:91], v[90:91]
    v_pk_mul_f32 v[112:113], v[92:93], v[92:93]
    v_pk_mul_f32 v[114:115], v[94:95], v[94:95]
    v_pk_mul_f32 v[116:117], v[96:97], v[96:97]
    v_pk_mul_f32 v[118:119], v[98:99], v[98:99]
    v_pk_fma_f32 v[104:105], v[104:105], v[4:5], v[4:5] op_sel:[0,0,1] op_sel_hi:[1,0,1]
    v_pk_fma_f32 v[106:107], v[106:107], v[4:5], v[4:5] op_sel:[0,0,1] op_sel_hi:[1,0,1]
    v_pk_fma_f32 v[108:109], v[108:109], v[4:5], v[4:5] op_sel:[0,0,1] op_sel_hi:[1,0,1]
    v_pk_fma_f32 v[110:111], v[110:111], v[4:5], v[4:5] op_sel:[0,0,1] op_sel_hi:[1,0,1]
    v_pk_fma_f32 v[112:113], v[112:113], v[4:5], v[4:5] op_sel:[0,0,1] op_sel_hi:[1,0,1]
    v_pk_fma_f32 v[114:115], v[114:115], v[4:5], v[4:5] op_sel:[0,0,1] op_sel_hi:[1,0,1]
    v_pk_fma_f32 v[116:117], v[116:117], v[4:5], v[4:5] op_sel:[0,0,1] op_sel_hi:[1,0,1]
    v_pk_fma_f32 v[118:119], v[118:119], v[4:5], v[4:5] op_sel:[0,0,1] op_sel_hi:[1,0,1]
    v_pk_mul_f32 v[104:105], v[104:105], v[84:85]
    v_pk_mul_f32 v[106:107], v[106:107], v[86:87]
    v_pk_mul_f32 v[108:109], v[108:109], v[88:89]
    v_pk_mul_f32 v[110:111], v[110:111], v[90:91]
    v_pk_mul_f32 v[112:113], v[112:113], v[92:93]
    v_pk_mul_f32 v[114:115], v[114:115], v[94:95]
    v_pk_mul_f32 v[116:117], v[116:117], v[96:97]
    v_pk_mul_f32 v[118:119], v[118:119], v[98:99]
    v_exp_f32 v104, v104
    v_exp_f32 v105, v105
    v_exp_f32 v106, v106
    v_exp_f32 v107, v107
    v_exp_f32 v108, v108
    v_exp_f32 v109, v109
    v_exp_f32 v110, v110
    v_exp_f32 v111, v111
    v_exp_f32 v112, v112
    v_exp_f32 v113, v113
    v_exp_f32 v114, v114
    v_exp_f32 v115, v115
    v_exp_f32 v116, v116
    v_exp_f32 v117, v117
    v_exp_f32 v118, v118
    v_exp_f32 v119, v119
    v_pk_add_f32 v[104:105], v[104:105], v[6:7]
    v_pk_add_f32 v[106:107], v[106:107], v[6:7]
    v_pk_add_f32 v[108:109], v[108:109], v[6:7]
    v_pk_add_f32 v[110:111], v[110:111], v[6:7]
    v_pk_add_f32 v[112:113], v[112:113], v[6:7]
    v_pk_add_f32 v[114:115], v[114:115], v[6:7]
    v_pk_add_f32 v[116:117], v[116:117], v[6:7]
    v_pk_add_f32 v[118:119], v[118:119], v[6:7]
    v_rcp_f32 v104, v104
    v_rcp_f32 v105, v105
    v_rcp_f32 v106, v106
    v_rcp_f32 v107, v107
    v_rcp_f32 v108, v108
    v_rcp_f32 v109, v109
    v_rcp_f32 v110, v110
    v_rcp_f32 v111, v111
    v_rcp_f32 v112, v112
    v_rcp_f32 v113, v113
    v_rcp_f32 v114, v114
    v_rcp_f32 v115, v115
    v_rcp_f32 v116, v116
    v_rcp_f32 v117, v117
    v_rcp_f32 v118, v118
    v_rcp_f32 v119, v119
    s_nop 0
    v_pk_mul_f32 v[84:85], v[84:85], v[104:105]
    v_pk_mul_f32 v[86:87], v[86:87], v[106:107]
    v_pk_mul_f32 v[88:89], v[88:89], v[108:109]
    v_pk_mul_f32 v[90:91], v[90:91], v[110:111]
    v_pk_mul_f32 v[92:93], v[92:93], v[112:113]
    v_pk_mul_f32 v[94:95], v[94:95], v[114:115]
    v_pk_mul_f32 v[96:97], v[96:97], v[116:117]
    v_pk_mul_f32 v[98:99], v[98:99], v[118:119]
    v_cvt_pk_bf16_f32 v84, v84, v85
    v_cvt_pk_bf16_f32 v85, v86, v87
    v_cvt_pk_bf16_f32 v86, v88, v89
    v_cvt_pk_bf16_f32 v87, v90, v91
    v_cvt_pk_bf16_f32 v88, v92, v93
    v_cvt_pk_bf16_f32 v89, v94, v95
    v_cvt_pk_bf16_f32 v90, v96, v97
    v_cvt_pk_bf16_f32 v91, v98, v99
L3_start:
    s_cmp_ge_u32 s2, 252
    s_cbranch_scc1 L3_exit
    s_load_dwordx2 s[4:5], s[0:1], 0
    s_load_dwordx2 s[6:7], s[0:1], 72
    s_load_dwordx2 s[48:49], s[0:1], 48
    v_lshlrev_b32 v7, 4, v0
    s_waitcnt lgkmcnt(0)
    s_barrier
    s_lshr_b32 s10, s2, 2
    s_mul_i32 s11, s3, 125
    s_lshl_b32 s54, s10, 1
    s_add_u32 s55, s54, s52
    s_min_u32 s55, s55, 124
    s_add_u32 s46, s55, s11
    s_mul_i32 s46, s46, 9216
    s_xor_b32 s56, s52, 1
    s_add_u32 s56, s56, s54
    s_min_u32 s56, s56, 124
    s_add_u32 s56, s56, s11
    s_mul_i32 s56, s56, 9216
    s_lshl_b32 s62, s28, 11
    s_add_u32 s47, s56, s62
    s_mul_i32 s59, s28, 9216
    s_add_u32 s59, s59, 7004160
    s_mul_i32 s57, s52, 63
    s_add_u32 s57, s57, s11
    s_add_u32 s58, s57, 63
    s_sub_u32 s58, s58, s52
    s_mul_i32 s33, s58, 9216
    s_add_u32 s57, s57, s28
    s_mul_i32 s32, s57, 9216
    s_add_u32 s58, s28, s52
    s_cmp_ge_u32 s58, 3
    s_cselect_b32 s29, 15, 16
    s_cselect_b32 s51, 9216, 0
    s_lshr_b32 s58, s10, 1
    s_and_b32 s58, s58, 15
    s_cmp_ge_u32 s58, s29
    s_cselect_b32 s58, 0, s58
    s_mul_i32 s58, s58, 36864
    s_add_u32 s31, s58, s32
    s_mul_i32 s37, s28, 27648
    s_mov_b32 s53, 9216
    s_mov_b32 s50, s51
    s_mov_b32 s41, 0x40000000
    s_mov_b32 s54, s41
    s_add_u32 m0, s62, 110592
    s_mov_b32 s62, 10146816
    s_mov_b32 s60, 0x4000
L3_s1:
    s_waitcnt vmcnt(0)
    v_cmp_ne_u64 vcc, s[68:69], v[22:23]
    s_sub_u32 s60, s60, 1
    s_cbranch_vccz L3_s1d
    buffer_load_dwordx2 v[22:23], v18, s[12:15], s62 offen sc1
    s_cbranch_scc0 L3_s1
L3_s1d:
    buffer_load_dwordx4 a[72:75], v7, s[12:15], s59 offen offset:0 sc1
    buffer_load_dwordx4 a[76:79], v7, s[12:15], s59 offen offset:1024 sc1
    buffer_load_dwordx4 a[80:83], v7, s[12:15], s59 offen offset:2048 sc1
    buffer_load_dwordx4 a[84:87], v7, s[12:15], s59 offen offset:3072 sc1
    s_add_u32 s59, s59, 4096
    buffer_load_dwordx4 a[88:91], v7, s[12:15], s59 offen offset:0 sc1
    buffer_load_dwordx4 a[92:95], v7, s[12:15], s59 offen offset:1024 sc1
    buffer_load_dwordx4 a[96:99], v7, s[12:15], s59 offen offset:2048 sc1
    buffer_load_dwordx4 a[100:103], v7, s[12:15], s59 offen offset:3072 sc1
    s_add_u32 s59, s59, 4096
    buffer_load_dwordx4 a[104:107], v7, s[12:15], s59 offen offset:0 sc1
    buffer_load_dwordx4 v7, s[12:15], s47 offen offset:0 sc1 lds
    buffer_load_dwordx4 v7, s[12:15], s47 offen offset:1024 sc1 lds
    buffer_load_dwordx4 v7, s[12:15], s47 offen offset:2048 sc1 lds
    s_cmp_ge_u32 s2, 250
    s_cbranch_scc1 L3_nt
    ds_read_b128 v[104:107], v14 offset:0
    ds_read_b128 v[108:111], v14 offset:16
    ds_read_b128 v[112:115], v14 offset:32
    ds_read_b128 v[116:119], v14 offset:48
    v_accvgpr_write_b32 a220, v84
    v_accvgpr_write_b32 a221, v85
    v_accvgpr_write_b32 a222, v86
    v_accvgpr_write_b32 a223, v87
    v_accvgpr_write_b32 a224, v88
    v_accvgpr_write_b32 a225, v89
    v_accvgpr_write_b32 a226, v90
    v_accvgpr_write_b32 a227, v91
    s_lshl_b32 s41, s28, 11
    s_add_u32 s57, s46, 4608000
    s_add_u32 s41, s41, s57
    s_and_b32 s54, s28, 1
    s_lshl3_add_u32 s54, s54, s57
    v_mov_b32 v15, 0x3be38e39
    s_waitcnt lgkmcnt(0)
    v_pk_add_f32 v[104:105], v[104:105], v[106:107]
    v_pk_add_f32 v[108:109], v[108:109], v[110:111]
    v_pk_add_f32 v[112:113], v[112:113], v[114:115]
    v_pk_add_f32 v[116:117], v[116:117], v[118:119]
    v_pk_add_f32 v[104:105], v[104:105], v[108:109]
    v_pk_add_f32 v[112:113], v[112:113], v[116:117]
    v_pk_add_f32 v[104:105], v[104:105], v[112:113]
    s_nop 0
    v_mul_f32 v104, 0x3be38e39, v104
    v_mul_f32 v106, v104, v104
    v_fma_f32 v105, v105, v15, -v106
    v_max_f32 v105, 0, v105
    v_add_f32 v105, 0x3727c5ac, v105
    v_rsq_f32 v106, v105
    v_cvt_pk_bf16_f32 v108, v68, v69
    v_mul_f32 v107, v104, v106
    v_cvt_pk_bf16_f32 v109, v70, v71
    v_pk_fma_f32 v[52:53], v[52:53], v[106:107], v[106:107] op_sel:[0,0,1] op_sel_hi:[1,0,1] neg_lo:[0,0,1] neg_hi:[0,0,1]
    v_pk_fma_f32 v[54:55], v[54:55], v[106:107], v[106:107] op_sel:[0,0,1] op_sel_hi:[1,0,1] neg_lo:[0,0,1] neg_hi:[0,0,1]
    v_pk_fma_f32 v[56:57], v[56:57], v[106:107], v[106:107] op_sel:[0,0,1] op_sel_hi:[1,0,1] neg_lo:[0,0,1] neg_hi:[0,0,1]
    v_pk_fma_f32 v[58:59], v[58:59], v[106:107], v[106:107] op_sel:[0,0,1] op_sel_hi:[1,0,1] neg_lo:[0,0,1] neg_hi:[0,0,1]
    v_pk_fma_f32 v[60:61], v[60:61], v[106:107], v[106:107] op_sel:[0,0,1] op_sel_hi:[1,0,1] neg_lo:[0,0,1] neg_hi:[0,0,1]
    v_pk_fma_f32 v[62:63], v[62:63], v[106:107], v[106:107] op_sel:[0,0,1] op_sel_hi:[1,0,1] neg_lo:[0,0,1] neg_hi:[0,0,1]
    v_pk_fma_f32 v[64:65], v[64:65], v[106:107], v[106:107] op_sel:[0,0,1] op_sel_hi:[1,0,1] neg_lo:[0,0,1] neg_hi:[0,0,1]
    v_pk_fma_f32 v[66:67], v[66:67], v[106:107], v[106:107] op_sel:[0,0,1] op_sel_hi:[1,0,1] neg_lo:[0,0,1] neg_hi:[0,0,1]
    v_pk_fma_f32 v[68:69], v[68:69], v[106:107], v[106:107] op_sel:[0,0,1] op_sel_hi:[1,0,1] neg_lo:[0,0,1] neg_hi:[0,0,1]
    v_pk_fma_f32 v[70:71], v[70:71], v[106:107], v[106:107] op_sel:[0,0,1] op_sel_hi:[1,0,1] neg_lo:[0,0,1] neg_hi:[0,0,1]
    s_cmp_ge_u32 s28, 2
    s_cselect_b64 vcc, -1, 0
    s_cselect_b32 s54, s54, 0x40000000
    v_cvt_pk_f16_f32 v52, v52, v53
    v_cvt_pk_f16_f32 v53, v54, v55
    v_cvt_pk_f16_f32 v54, v56, v57
    v_cvt_pk_f16_f32 v55, v58, v59
    v_cvt_pk_f16_f32 v56, v60, v61
    v_cvt_pk_f16_f32 v57, v62, v63
    v_cvt_pk_f16_f32 v58, v64, v65
    v_cvt_pk_f16_f32 v59, v66, v67
    v_cvt_pk_f16_f32 v60, v68, v69
    v_cvt_pk_f16_f32 v61, v70, v71
    v_cndmask_b32 v108, v108, v60, vcc
    v_cndmask_b32 v109, v109, v61, vcc
    v_accvgpr_write_b32 a228, v52
    v_accvgpr_write_b32 a229, v53
    v_accvgpr_write_b32 a230, v54
    v_accvgpr_write_b32 a231, v55
    v_accvgpr_write_b32 a232, v56
    v_accvgpr_write_b32 a233, v57
    v_accvgpr_write_b32 a234, v58
    v_accvgpr_write_b32 a235, v59
    v_accvgpr_write_b32 a236, v108
    v_accvgpr_write_b32 a237, v109
L3_nt:
    s_mov_b32 s24, s48
    s_and_b32 s25, s49, 0xffff
    s_mov_b32 s26, 1440
    s_mov_b32 s27, 0x00020000
    s_cmp_eq_u32 s28, 3
    s_cbranch_scc0 L3_p3
    v_lshrrev_b32 v10, 2, v0
    v_and_b32 v11, 3, v0
    v_lshlrev_b32 v12, 4, v11
    v_lshl_add_u32 v12, v10, 9, v12
    s_cmp_eq_u32 s55, 0
    s_cselect_b32 s57, 0x40000000, s53
    s_add_u32 s57, s57, 4294958560
    s_cmp_eq_u32 s55, 124
    s_cselect_b32 s58, 0x40000000, s53
    s_add_u32 s58, s58, 9184
    v_mov_b32 v13, s57
    v_mov_b32 v14, s58
    v_cmp_gt_u32 vcc, 2, v11
    s_nop 1
    v_cndmask_b32 v13, v14, v13, vcc
    v_add_u32 v12, v12, v13
    v_accvgpr_write_b32 a255, v12
L3_p3:
    s_mov_b32 s16, s4
    s_and_b32 s17, s5, 0xffff
    s_mov_b32 s18, 2304000
    s_mov_b32 s19, 0x00020000
    s_mov_b32 s20, s6
    s_and_b32 s21, s7, 0xffff
    s_mov_b32 s22, 2304000
    s_mov_b32 s23, 0x00020000
    s_mul_i32 s34, s28, 18432
    s_add_u32 s34, s34, 6912000
    s_add_u32 s35, s34, 9216
    s_mul_i32 s36, s28, 9216
    s_add_u32 s36, s36, 6985728
    s_cmp_ge_u32 s28, 2
    s_cselect_b32 s36, 0x40000000, s36
    s_mov_b32 s30, s29
    s_mov_b32 s61, 14
    s_add_u32 s57, s37, s51
    v_and_b32 v10, 31, v0
    v_lshrrev_b32 v11, 5, v0
    v_lshlrev_b32 v12, 2, v11
    v_xor_b32 v12, v10, v12
    v_lshlrev_b32 v12, 4, v12
    v_lshl_add_u32 v16, v11, 9, v12
    v_xor_b32 v17, 0x80, v16
    v_add_u32 v1, s57, v16
    v_add_u32 v2, s57, v17
    v_add_u32 v16, 110592, v16
    v_add_u32 v17, 110592, v17
    v_bfe_u32 v12, v0, 4, 1
    v_bfe_u32 v13, v0, 1, 1
    v_lshl_add_u32 v13, v12, 1, v13
    v_bfe_u32 v14, v0, 2, 2
    v_lshl_add_u32 v14, v11, 2, v14
    v_lshlrev_b32 v15, 2, v13
    v_xor_b32 v14, v14, v15
    v_lshlrev_b32 v14, 4, v14
    v_lshl_add_u32 v14, v13, 9, v14
    v_and_b32 v15, 1, v0
    v_lshl_add_u32 v14, v15, 3, v14
    v_add_u32 v3, s57, v14
    v_xor_b32 v14, 0x80, v14
    v_add_u32 v4, s57, v14
    v_cmp_eq_u32 vcc, 1, v12
    v_mov_b32 v15, 147456
    v_xor_b32 v8, 1, v12
    v_add_u32 v14, 8192, v3
    v_cndmask_b32 v5, v14, v15, vcc
    v_add_u32 v14, 8192, v4
    v_cndmask_b32 v6, v14, v15, vcc
    v_mov_b32 v12, 0x3f803f80
    v_mov_b32 v13, 0x3f803f80
    v_lshl_add_u32 v14, v0, 3, v15
    ds_write_b64 v14, v[12:13]
    v_mov_b32 v12, 0
    v_mov_b32 v13, 0
    s_mov_b32 s44, 0
    s_mov_b32 s42, 0
    s_mov_b32 s45, 0
    s_mov_b32 s43, 0
    ds_read_b128 a[184:187], v16 offset:9216
    ds_read_b128 a[188:191], v17 offset:10240
    ds_read_b128 a[192:195], v16 offset:11264
    ds_read_b128 a[196:199], v17 offset:12288
    ds_read_b128 a[200:203], v16 offset:13312
    ds_read_b128 a[204:207], v17 offset:14336
    ds_read_b128 a[208:211], v16 offset:15360
    ds_read_b128 a[212:215], v17 offset:16384
    ds_read_b128 a[216:219], v16 offset:17408
    s_sub_u32 s58, s2, 2
    s_cselect_b32 s58, s2, s58
    s_add_u32 s57, s2, 2
    s_cmp_gt_u32 s57, 251
    s_cselect_b32 s57, s2, s57
    v_mov_b32 v19, s57
    v_mov_b32 v20, s58
    v_cmp_gt_u32 vcc, 4, v0
    v_and_b32 v21, 3, v0
    v_lshlrev_b32 v21, 3, v21
    v_cndmask_b32 v19, v19, v20, vcc
    v_lshl_add_u32 v19, v19, 8, v21
    v_add_u32 v19, 128, v19
    v_add_u32 v20, 245, v0
    v_cmp_gt_u32 vcc, 8, v0
    v_min_u32 v20, 255, v20
    v_lshlrev_b32 v20, 8, v20
    v_cndmask_b32 v9, v20, v19, vcc
    s_cmp_ge_u32 s28, 2
    s_cselect_b32 s58, 0x40000000, 0
    s_add_u32 s58, s58, 7041024
    buffer_load_dwordx4 a[108:111], v7, s[12:15], s58 offen offset:0 sc1
    v_pk_mul_f32 v[96:97], v[12:13], v[12:13]
    v_pk_mul_f32 v[98:99], v[12:13], v[12:13]
    v_pk_mul_f32 v[100:101], v[12:13], v[12:13]
    v_pk_mul_f32 v[102:103], v[12:13], v[12:13]
    v_pk_mul_f32 v[104:105], v[12:13], v[12:13]
    v_pk_mul_f32 v[106:107], v[12:13], v[12:13]
    v_pk_mul_f32 v[108:109], v[12:13], v[12:13]
    v_pk_mul_f32 v[110:111], v[12:13], v[12:13]
    v_pk_mul_f32 v[112:113], v[12:13], v[12:13]
    buffer_load_dwordx4 a[112:115], v7, s[12:15], s58 offen offset:1024 sc1
    v_pk_mul_f32 v[114:115], v[12:13], v[12:13]
    v_pk_mul_f32 v[116:117], v[12:13], v[12:13]
    v_pk_mul_f32 v[118:119], v[12:13], v[12:13]
    v_pk_mul_f32 v[120:121], v[12:13], v[12:13]
    v_pk_mul_f32 v[122:123], v[12:13], v[12:13]
    v_pk_mul_f32 v[124:125], v[12:13], v[12:13]
    v_pk_mul_f32 v[126:127], v[12:13], v[12:13]
    v_pk_mul_f32 v[128:129], v[12:13], v[12:13]
    v_pk_mul_f32 v[130:131], v[12:13], v[12:13]
    buffer_load_dwordx4 a[116:119], v7, s[12:15], s58 offen offset:2048 sc1
    v_pk_mul_f32 v[132:133], v[12:13], v[12:13]
    v_pk_mul_f32 v[134:135], v[12:13], v[12:13]
    v_pk_mul_f32 v[136:137], v[12:13], v[12:13]
    v_pk_mul_f32 v[138:139], v[12:13], v[12:13]
    v_pk_mul_f32 v[140:141], v[12:13], v[12:13]
    v_pk_mul_f32 v[142:143], v[12:13], v[12:13]
    v_pk_mul_f32 v[144:145], v[12:13], v[12:13]
    v_pk_mul_f32 v[146:147], v[12:13], v[12:13]
    v_pk_mul_f32 v[148:149], v[12:13], v[12:13]
    buffer_load_dwordx4 a[120:123], v7, s[12:15], s58 offen offset:3072 sc1
    v_pk_mul_f32 v[150:151], v[12:13], v[12:13]
    v_pk_mul_f32 v[152:153], v[12:13], v[12:13]
    v_pk_mul_f32 v[154:155], v[12:13], v[12:13]
    v_pk_mul_f32 v[156:157], v[12:13], v[12:13]
    v_pk_mul_f32 v[158:159], v[12:13], v[12:13]
    v_pk_mul_f32 v[160:161], v[12:13], v[12:13]
    v_pk_mul_f32 v[162:163], v[12:13], v[12:13]
    v_pk_mul_f32 v[164:165], v[12:13], v[12:13]
    v_pk_mul_f32 v[166:167], v[12:13], v[12:13]
    s_add_u32 s58, s58, 4096
    buffer_load_dwordx4 a[124:127], v7, s[12:15], s58 offen offset:0 sc1
    v_pk_mul_f32 v[168:169], v[12:13], v[12:13]
    v_pk_mul_f32 v[170:171], v[12:13], v[12:13]
    v_pk_mul_f32 v[172:173], v[12:13], v[12:13]
    v_pk_mul_f32 v[174:175], v[12:13], v[12:13]
    v_pk_mul_f32 v[176:177], v[12:13], v[12:13]
    v_pk_mul_f32 v[178:179], v[12:13], v[12:13]
    v_pk_mul_f32 v[180:181], v[12:13], v[12:13]
    v_pk_mul_f32 v[182:183], v[12:13], v[12:13]
    v_pk_mul_f32 v[184:185], v[12:13], v[12:13]
    buffer_load_dwordx4 a[128:131], v7, s[12:15], s58 offen offset:1024 sc1
    v_pk_mul_f32 v[186:187], v[12:13], v[12:13]
    v_pk_mul_f32 v[188:189], v[12:13], v[12:13]
    v_pk_mul_f32 v[190:191], v[12:13], v[12:13]
    v_pk_mul_f32 v[192:193], v[12:13], v[12:13]
    v_pk_mul_f32 v[194:195], v[12:13], v[12:13]
    v_pk_mul_f32 v[196:197], v[12:13], v[12:13]
    v_pk_mul_f32 v[198:199], v[12:13], v[12:13]
    v_pk_mul_f32 v[200:201], v[12:13], v[12:13]
    v_pk_mul_f32 v[202:203], v[12:13], v[12:13]
    buffer_load_dwordx4 a[132:135], v7, s[12:15], s58 offen offset:2048 sc1
    v_pk_mul_f32 v[204:205], v[12:13], v[12:13]
    v_pk_mul_f32 v[206:207], v[12:13], v[12:13]
    v_pk_mul_f32 v[208:209], v[12:13], v[12:13]
    v_pk_mul_f32 v[210:211], v[12:13], v[12:13]
    v_pk_mul_f32 v[212:213], v[12:13], v[12:13]
    v_pk_mul_f32 v[214:215], v[12:13], v[12:13]
    v_pk_mul_f32 v[216:217], v[12:13], v[12:13]
    v_pk_mul_f32 v[218:219], v[12:13], v[12:13]
    v_pk_mul_f32 v[220:221], v[12:13], v[12:13]
    buffer_load_dwordx4 a[136:139], v7, s[12:15], s58 offen offset:3072 sc1
    v_pk_mul_f32 v[222:223], v[12:13], v[12:13]
    v_pk_mul_f32 v[224:225], v[12:13], v[12:13]
    v_pk_mul_f32 v[226:227], v[12:13], v[12:13]
    v_pk_mul_f32 v[228:229], v[12:13], v[12:13]
    v_pk_mul_f32 v[230:231], v[12:13], v[12:13]
    v_pk_mul_f32 v[232:233], v[12:13], v[12:13]
    v_pk_mul_f32 v[234:235], v[12:13], v[12:13]
    v_pk_mul_f32 v[236:237], v[12:13], v[12:13]
    v_pk_mul_f32 v[238:239], v[12:13], v[12:13]
    s_add_u32 s58, s58, 4096
    buffer_load_dwordx4 a[140:143], v7, s[12:15], s58 offen offset:0 sc1
    v_pk_mul_f32 v[240:241], v[12:13], v[12:13]
    v_pk_mul_f32 v[242:243], v[12:13], v[12:13]
    v_pk_mul_f32 v[244:245], v[12:13], v[12:13]
    v_pk_mul_f32 v[246:247], v[12:13], v[12:13]
    v_pk_mul_f32 v[248:249], v[12:13], v[12:13]
    v_pk_mul_f32 v[250:251], v[12:13], v[12:13]
    v_pk_mul_f32 v[252:253], v[12:13], v[12:13]
    v_pk_mul_f32 v[254:255], v[12:13], v[12:13]
    s_waitcnt lgkmcnt(0)
    s_waitcnt vmcnt(20)
    v_mfma_f32_32x32x16_bf16 v[48:63], a[72:75], a[184:187], 0
    s_add_u32 s38, s37, s50
    s_mov_b32 s47, s31
    s_add_u32 m0, s38, 0
    s_nop 0
    buffer_load_dwordx4 v7, s[12:15], s47 offen offset:0 sc1 lds
    s_waitcnt vmcnt(20)
    v_mfma_f32_32x32x16_bf16 v[48:63], a[76:79], a[188:191], v[48:63]
    buffer_load_dwordx4 v7, s[12:15], s47 offen offset:1024 sc1 lds
    s_waitcnt vmcnt(20)
    v_mfma_f32_32x32x16_bf16 v[48:63], a[80:83], a[192:195], v[48:63]
    buffer_load_dwordx4 v7, s[12:15], s47 offen offset:2048 sc1 lds
    s_waitcnt vmcnt(20)
    v_mfma_f32_32x32x16_bf16 v[48:63], a[84:87], a[196:199], v[48:63]
    buffer_load_dwordx4 v7, s[12:15], s47 offen offset:3072 sc1 lds
    s_waitcnt vmcnt(20)
    v_mfma_f32_32x32x16_bf16 v[48:63], a[88:91], a[200:203], v[48:63]
    s_add_u32 m0, s38, 4096
    s_add_u32 s47, s47, 4096
    buffer_load_dwordx4 v7, s[12:15], s47 offen offset:0 sc1 lds
    s_waitcnt vmcnt(20)
    v_mfma_f32_32x32x16_bf16 v[48:63], a[92:95], a[204:207], v[48:63]
    buffer_load_dwordx4 v7, s[12:15], s47 offen offset:1024 sc1 lds
    s_waitcnt vmcnt(20)
    v_mfma_f32_32x32x16_bf16 v[48:63], a[96:99], a[208:211], v[48:63]
    buffer_load_dwordx4 v7, s[12:15], s47 offen offset:2048 sc1 lds
    s_waitcnt vmcnt(20)
    v_mfma_f32_32x32x16_bf16 v[48:63], a[100:103], a[212:215], v[48:63]
    buffer_load_dwordx4 v7, s[12:15], s47 offen offset:3072 sc1 lds
    s_waitcnt vmcnt(20)
    v_mfma_f32_32x32x16_bf16 v[48:63], a[104:107], a[216:219], v[48:63]
    s_add_u32 m0, s38, 8192
    s_add_u32 s47, s47, 4096
    buffer_load_dwordx4 v7, s[12:15], s47 offen offset:0 sc1 lds
    s_add_u32 s31, s31, 36864
    s_cmp_ge_u32 s31, s33
    s_cselect_b32 s31, s32, s31
    s_cmp_eq_u32 s50, 18432
    s_cselect_b32 s39, 4294948864, s53
    s_add_u32 s50, s50, s39
    s_waitcnt vmcnt(18)
    s_barrier
    ds_read_b128 a[148:151], v16 offset:0
    ds_read_b128 a[152:155], v17 offset:1024
    ds_read_b128 a[156:159], v16 offset:2048
    ds_read_b128 a[160:163], v17 offset:3072
    ds_read_b128 a[164:167], v16 offset:4096
    ds_read_b128 a[168:171], v17 offset:5120
    ds_read_b128 a[172:175], v16 offset:6144
    ds_read_b128 a[176:179], v17 offset:7168
    ds_read_b128 a[180:183], v16 offset:8192
    s_lshl_b32 s57, s28, 11
    v_add_u32 v10, 129024, v7
    v_add_u32 v11, s57, v10
    v_cvt_pk_bf16_f32 v24, v48, v49
    v_cvt_pk_bf16_f32 v25, v50, v51
    v_cvt_pk_bf16_f32 v26, v52, v53
    v_cvt_pk_bf16_f32 v27, v54, v55
    v_cvt_pk_bf16_f32 v28, v56, v57
    v_cvt_pk_bf16_f32 v29, v58, v59
    v_cvt_pk_bf16_f32 v30, v60, v61
    v_cvt_pk_bf16_f32 v31, v62, v63
    s_waitcnt lgkmcnt(8)
    v_mfma_f32_32x32x16_bf16 v[32:47], a[72:75], a[148:151], 0
    s_waitcnt lgkmcnt(7)
    v_mfma_f32_32x32x16_bf16 v[32:47], a[76:79], a[152:155], v[32:47]
    s_add_u32 s38, s37, s50
    s_mov_b32 s47, s31
    s_add_u32 m0, s38, 0
    s_nop 0
    buffer_load_dwordx4 v7, s[12:15], s47 offen offset:0 sc1 lds
    s_waitcnt lgkmcnt(6)
    v_mfma_f32_32x32x16_bf16 v[32:47], a[80:83], a[156:159], v[32:47]
    s_waitcnt lgkmcnt(5)
    v_mfma_f32_32x32x16_bf16 v[32:47], a[84:87], a[160:163], v[32:47]
    buffer_load_dwordx4 v7, s[12:15], s47 offen offset:1024 sc1 lds
    s_waitcnt lgkmcnt(4)
    v_mfma_f32_32x32x16_bf16 v[32:47], a[88:91], a[164:167], v[32:47]
    s_waitcnt lgkmcnt(3)
    v_mfma_f32_32x32x16_bf16 v[32:47], a[92:95], a[168:171], v[32:47]
    buffer_load_dwordx4 v7, s[12:15], s47 offen offset:2048 sc1 lds
    s_waitcnt lgkmcnt(2)
    v_mfma_f32_32x32x16_bf16 v[32:47], a[96:99], a[172:175], v[32:47]
    s_waitcnt lgkmcnt(1)
    v_mfma_f32_32x32x16_bf16 v[32:47], a[100:103], a[176:179], v[32:47]
    buffer_load_dwordx4 v7, s[12:15], s47 offen offset:3072 sc1 lds
    s_waitcnt lgkmcnt(0)
    v_mfma_f32_32x32x16_bf16 v[32:47], a[104:107], a[180:183], v[32:47]
    ds_write_b128 v11, v[24:27] offset:9216
    ds_write_b128 v11, v[28:31] offset:10240
    s_nop 4
    s_waitcnt vmcnt(13)
    s_cmp_eq_u32 s28, 1
    s_cbranch_scc1 L3_q1
    s_cmp_eq_u32 s28, 0
    s_cbranch_scc0 L3_q2
    v_mfma_f32_32x32x16_bf16 v[48:63], a[108:111], a[148:151], 0
    v_mfma_f32_32x32x16_bf16 v[48:63], a[112:115], a[152:155], v[48:63]
    v_mfma_f32_32x32x16_bf16 v[48:63], a[116:119], a[156:159], v[48:63]
    v_mfma_f32_32x32x16_bf16 v[48:63], a[120:123], a[160:163], v[48:63]
    v_mfma_f32_32x32x16_bf16 v[48:63], a[124:127], a[164:167], v[48:63]
    v_mfma_f32_32x32x16_bf16 v[48:63], a[128:131], a[168:171], v[48:63]
    v_mfma_f32_32x32x16_bf16 v[48:63], a[132:135], a[172:175], v[48:63]
    v_mfma_f32_32x32x16_bf16 v[48:63], a[136:139], a[176:179], v[48:63]
    v_mfma_f32_32x32x16_bf16 v[48:63], a[140:143], a[180:183], v[48:63]
    s_nop 7
    s_nop 3
    v_cvt_pk_bf16_f32 v12, v48, v49
    v_cvt_pk_bf16_f32 v13, v50, v51
    v_cvt_pk_bf16_f32 v14, v52, v53
    v_cvt_pk_bf16_f32 v15, v54, v55
    ds_write_b128 v10, v[12:15] offset:8192
    s_branch L3_q2
L3_q1:
    v_mfma_f32_32x32x16_bf16 v[48:63], a[108:111], a[184:187], 0
    v_mfma_f32_32x32x16_bf16 v[48:63], a[112:115], a[188:191], v[48:63]
    v_mfma_f32_32x32x16_bf16 v[48:63], a[116:119], a[192:195], v[48:63]
    v_mfma_f32_32x32x16_bf16 v[48:63], a[120:123], a[196:199], v[48:63]
    v_mfma_f32_32x32x16_bf16 v[48:63], a[124:127], a[200:203], v[48:63]
    v_mfma_f32_32x32x16_bf16 v[48:63], a[128:131], a[204:207], v[48:63]
    v_mfma_f32_32x32x16_bf16 v[48:63], a[132:135], a[208:211], v[48:63]
    v_mfma_f32_32x32x16_bf16 v[48:63], a[136:139], a[212:215], v[48:63]
    v_mfma_f32_32x32x16_bf16 v[48:63], a[140:143], a[216:219], v[48:63]
    s_nop 7
    s_nop 3
    v_cvt_pk_bf16_f32 v12, v48, v49
    v_cvt_pk_bf16_f32 v13, v50, v51
    v_cvt_pk_bf16_f32 v14, v52, v53
    v_cvt_pk_bf16_f32 v15, v54, v55
    ds_write_b128 v10, v[12:15] offset:17408
L3_q2:
    v_cvt_pk_bf16_f32 v16, v32, v33
    v_cvt_pk_bf16_f32 v17, v34, v35
    v_cvt_pk_bf16_f32 v18, v36, v37
    v_cvt_pk_bf16_f32 v19, v38, v39
    v_cvt_pk_bf16_f32 v20, v40, v41
    v_cvt_pk_bf16_f32 v21, v42, v43
    v_cvt_pk_bf16_f32 v22, v44, v45
    v_cvt_pk_bf16_f32 v23, v46, v47
    ds_write_b128 v11, v[16:19]
    ds_write_b128 v11, v[20:23] offset:1024
    s_waitcnt vmcnt(4)
    ds_read_b128 a[72:75], v1 offset:0
    ds_read_b128 a[76:79], v2 offset:1024
    ds_read_b128 a[80:83], v1 offset:2048
    ds_read_b128 a[84:87], v2 offset:3072
    ds_read_b128 a[88:91], v1 offset:4096
    ds_read_b128 a[92:95], v2 offset:5120
    ds_read_b128 a[96:99], v1 offset:6144
    ds_read_b128 a[100:103], v2 offset:7168
    ds_read_b128 a[104:107], v1 offset:8192
    s_add_u32 m0, s38, 4096
    s_add_u32 s47, s47, 4096
    buffer_load_dwordx4 v7, s[12:15], s47 offen offset:0 sc1 lds
    buffer_load_dwordx4 v7, s[12:15], s47 offen offset:1024 sc1 lds
    buffer_load_dwordx4 v7, s[12:15], s47 offen offset:2048 sc1 lds
    buffer_load_dwordx4 v7, s[12:15], s47 offen offset:3072 sc1 lds
    s_add_u32 m0, s38, 8192
    s_add_u32 s47, s47, 4096
    buffer_load_dwordx4 v7, s[12:15], s47 offen offset:0 sc1 lds
    s_add_u32 s31, s31, 36864
    s_cmp_ge_u32 s31, s33
    s_cselect_b32 s31, s32, s31
    s_cmp_eq_u32 s50, 18432
    s_cselect_b32 s39, 4294948864, s53
    s_add_u32 s50, s50, s39
    s_waitcnt lgkmcnt(0)
    s_barrier
    ds_read_b128 a[0:3], v10 offset:0
    ds_read_b128 a[4:7], v10 offset:1024
    ds_read_b128 a[8:11], v10 offset:2048
    ds_read_b128 a[12:15], v10 offset:3072
    ds_read_b128 a[16:19], v10 offset:4096
    ds_read_b128 a[20:23], v10 offset:5120
    ds_read_b128 a[24:27], v10 offset:6144
    ds_read_b128 a[28:31], v10 offset:7168
    ds_read_b128 a[32:35], v10 offset:8192
    s_waitcnt lgkmcnt(8)
    v_mfma_f32_32x32x16_bf16 v[32:47], a[72:75], a[0:3], 0
    ds_read_b128 a[36:39], v10 offset:9216
    ds_read_b128 a[40:43], v10 offset:10240
    s_waitcnt lgkmcnt(9)
    v_mfma_f32_32x32x16_bf16 v[32:47], a[76:79], a[4:7], v[32:47]
    ds_read_b128 a[44:47], v10 offset:11264
    ds_read_b128 a[48:51], v10 offset:12288
    s_add_u32 s38, s37, s50
    s_mov_b32 s47, s31
    s_add_u32 m0, s38, 0
    s_nop 0
    buffer_load_dwordx4 v7, s[12:15], s47 offen offset:0 sc1 lds
    s_waitcnt lgkmcnt(10)
    v_mfma_f32_32x32x16_bf16 v[32:47], a[80:83], a[8:11], v[32:47]
    ds_read_b128 a[52:55], v10 offset:13312
    ds_read_b128 a[56:59], v10 offset:14336
    s_waitcnt lgkmcnt(11)
    v_mfma_f32_32x32x16_bf16 v[32:47], a[84:87], a[12:15], v[32:47]
    ds_read_b128 a[60:63], v10 offset:15360
    ds_read_b128 a[64:67], v10 offset:16384
    buffer_load_dwordx4 v7, s[12:15], s47 offen offset:1024 sc1 lds
    s_waitcnt lgkmcnt(12)
    v_mfma_f32_32x32x16_bf16 v[32:47], a[88:91], a[16:19], v[32:47]
    ds_read_b128 a[68:71], v10 offset:17408
    ds_read_b64_tr_b16 a[108:109], v3 offset:0
    s_waitcnt lgkmcnt(13)
    v_mfma_f32_32x32x16_bf16 v[32:47], a[92:95], a[20:23], v[32:47]
    ds_read_b64_tr_b16 a[110:111], v4 offset:0
    ds_read_b64_tr_b16 a[112:113], v3 offset:2048
    buffer_load_dwordx4 v7, s[12:15], s47 offen offset:2048 sc1 lds
    s_waitcnt lgkmcnt(14)
    v_mfma_f32_32x32x16_bf16 v[32:47], a[96:99], a[24:27], v[32:47]
    ds_read_b64_tr_b16 a[114:115], v4 offset:2048
    ds_read_b64_tr_b16 a[116:117], v3 offset:4096
    s_waitcnt lgkmcnt(15)
    v_mfma_f32_32x32x16_bf16 v[32:47], a[100:103], a[28:31], v[32:47]
    ds_read_b64_tr_b16 a[118:119], v4 offset:4096
    ds_read_b64_tr_b16 a[120:121], v3 offset:6144
    buffer_load_dwordx4 v7, s[12:15], s47 offen offset:3072 sc1 lds
    s_waitcnt lgkmcnt(15)
    v_mfma_f32_32x32x16_bf16 v[32:47], a[104:107], a[32:35], v[32:47]
    ds_read_b64_tr_b16 a[122:123], v4 offset:6144
    ds_read_b64_tr_b16 a[124:125], v5 offset:0
    ds_read_b64_tr_b16 a[126:127], v6 offset:0
    s_nop 6
    s_waitcnt lgkmcnt(10)
    v_mfma_f32_32x32x16_bf16 v[48:63], a[72:75], a[36:39], 0
    s_add_u32 m0, s38, 4096
    s_add_u32 s47, s47, 4096
    buffer_load_dwordx4 v7, s[12:15], s47 offen offset:0 sc1 lds
    v_max3_f32 v28, v32, v33, v34
    v_max3_f32 v29, v35, v36, v37
    v_max3_f32 v28, v28, v38, v39
    v_max3_f32 v29, v29, v40, v41
    v_max3_f32 v28, v28, v42, v43
    v_max3_f32 v29, v29, v44, v45
    v_mfma_f32_32x32x16_bf16 v[48:63], a[76:79], a[40:43], v[48:63]
    v_max3_f32 v28, v28, v46, v47
    v_max_f32 v28, v28, v29
    v_mov_b32 v29, v28
    s_nop 1
    v_permlane32_swap_b32 v28, v29
    s_nop 1
    v_mfma_f32_32x32x16_bf16 v[48:63], a[80:83], a[44:47], v[48:63]
    buffer_load_dwordx4 v7, s[12:15], s47 offen offset:1024 sc1 lds
    v_max_f32 v28, v28, v29
    v_sub_f32 v28, 0xc1000000, v28
    v_add_f32 v32, v32, v28
    v_add_f32 v33, v33, v28
    v_add_f32 v34, v34, v28
    v_add_f32 v35, v35, v28
    v_mfma_f32_32x32x16_bf16 v[48:63], a[84:87], a[48:51], v[48:63]
    v_add_f32 v36, v36, v28
    v_add_f32 v37, v37, v28
    v_add_f32 v38, v38, v28
    v_add_f32 v39, v39, v28
    v_add_f32 v40, v40, v28
    v_add_f32 v41, v41, v28
    v_mfma_f32_32x32x16_bf16 v[48:63], a[88:91], a[52:55], v[48:63]
    buffer_load_dwordx4 v7, s[12:15], s47 offen offset:2048 sc1 lds
    v_add_f32 v42, v42, v28
    v_add_f32 v43, v43, v28
    v_add_f32 v44, v44, v28
    v_add_f32 v45, v45, v28
    v_add_f32 v46, v46, v28
    v_add_f32 v47, v47, v28
    v_mfma_f32_32x32x16_bf16 v[48:63], a[92:95], a[56:59], v[48:63]
    v_mov_b32 v64, v28
    v_mov_b32 v65, v28
    v_mov_b32 v66, v28
    v_mov_b32 v67, v28
    v_mov_b32 v68, v28
    v_mov_b32 v69, v28
    v_mfma_f32_32x32x16_bf16 v[48:63], a[96:99], a[60:63], v[48:63]
    buffer_load_dwordx4 v7, s[12:15], s47 offen offset:3072 sc1 lds
    v_mov_b32 v70, v28
    v_mov_b32 v71, v28
    v_mov_b32 v72, v28
    v_mov_b32 v73, v28
    v_mov_b32 v74, v28
    v_mov_b32 v75, v28
    v_mfma_f32_32x32x16_bf16 v[48:63], a[100:103], a[64:67], v[48:63]
    v_mov_b32 v76, v28
    v_mov_b32 v77, v28
    v_mov_b32 v78, v28
    v_mov_b32 v79, v28
    v_exp_f32 v16, v32
    v_exp_f32 v17, v33
    v_mfma_f32_32x32x16_bf16 v[48:63], a[104:107], a[68:71], v[48:63]
    s_add_u32 m0, s38, 8192
    s_add_u32 s47, s47, 4096
    buffer_load_dwordx4 v7, s[12:15], s47 offen offset:0 sc1 lds
    v_exp_f32 v18, v34
    v_cvt_pk_bf16_f32 v24, v16, v17
    v_exp_f32 v19, v35
    v_exp_f32 v20, v36
    v_cvt_pk_bf16_f32 v25, v18, v19
    v_exp_f32 v21, v37
    v_exp_f32 v22, v38
    v_cvt_pk_bf16_f32 v26, v20, v21
    v_exp_f32 v23, v39
    v_or3_b32 v12, v24, v25, v26
    s_add_u32 s31, s31, 36864
    s_cmp_ge_u32 s31, s33
    s_cselect_b32 s31, s32, s31
    s_cmp_eq_u32 s50, 18432
    s_cselect_b32 s39, 4294948864, s53
    s_add_u32 s50, s50, s39
    s_cmp_eq_u32 s50, 18432
    s_cselect_b32 s39, 4294948864, s53
    s_add_u32 s50, s50, s39
    v_add_u32 v1, s39, v1
    v_add_u32 v2, s39, v2
    v_max3_f32 v28, v48, v49, v50
    v_max3_f32 v29, v51, v52, v53
    v_max3_f32 v28, v28, v54, v55
    v_max3_f32 v29, v29, v56, v57
    v_max3_f32 v28, v28, v58, v59
    v_max3_f32 v29, v29, v60, v61
    v_max3_f32 v28, v28, v62, v63
    v_max_f32 v28, v28, v29
    v_mov_b32 v29, v28
    s_nop 1
    v_permlane32_swap_b32 v28, v29
    s_nop 1
    v_max_f32 v28, v28, v29
    v_sub_f32 v28, 0xc1000000, v28
    v_mov_b32 v29, v28
    v_pk_mul_f32 v[80:81], v[28:29], 1.0 op_sel_hi:[1,0]
    v_pk_mul_f32 v[82:83], v[28:29], 1.0 op_sel_hi:[1,0]
    v_pk_mul_f32 v[84:85], v[28:29], 1.0 op_sel_hi:[1,0]
    v_pk_mul_f32 v[86:87], v[28:29], 1.0 op_sel_hi:[1,0]
    v_pk_mul_f32 v[88:89], v[28:29], 1.0 op_sel_hi:[1,0]
    v_pk_mul_f32 v[90:91], v[28:29], 1.0 op_sel_hi:[1,0]
    v_pk_mul_f32 v[92:93], v[28:29], 1.0 op_sel_hi:[1,0]
    v_pk_mul_f32 v[94:95], v[28:29], 1.0 op_sel_hi:[1,0]
    s_nop 1
    .p2align 3
L3_loop:
    v_mfma_f32_32x32x16_bf16 v[48:63], a[72:75], a[36:39], v[80:95]
    ds_read_b64_tr_b16 a[128:129], v3 offset:256
    ds_read_b64_tr_b16 a[130:131], v4 offset:256
    v_exp_f32 v16, v40
    v_cvt_pk_bf16_f32 v27, v22, v23
    s_add_u32 s38, s37, s51
    v_mfma_f32_32x32x16_bf16 v[48:63], a[76:79], a[40:43], v[48:63]
    ds_read_b64_tr_b16 a[132:133], v3 offset:2304
    ds_read_b64_tr_b16 a[134:135], v4 offset:2304
    v_exp_f32 v17, v41
    v_exp_f32 v18, v42
    v_mfma_f32_32x32x16_bf16 v[48:63], a[80:83], a[44:47], v[48:63]
    ds_read_b64_tr_b16 a[136:137], v3 offset:4352
    ds_read_b64_tr_b16 a[138:139], v4 offset:4352
    v_cvt_pk_bf16_f32 v28, v16, v17
    v_exp_f32 v19, v43
    s_mov_b32 s51, s50
    v_mfma_f32_32x32x16_bf16 v[48:63], a[84:87], a[48:51], v[48:63]
    ds_read_b64_tr_b16 a[140:141], v3 offset:6400
    ds_read_b64_tr_b16 a[142:143], v4 offset:6400
    v_exp_f32 v20, v44
    v_cvt_pk_bf16_f32 v29, v18, v19
    v_mfma_f32_32x32x16_bf16 v[48:63], a[88:91], a[52:55], v[48:63]
    ds_read_b64_tr_b16 a[144:145], v5 offset:256
    ds_read_b64_tr_b16 a[146:147], v6 offset:256
    v_exp_f32 v21, v45
    v_exp_f32 v22, v46
    v_mfma_f32_32x32x16_bf16 v[48:63], a[92:95], a[56:59], v[48:63]
    v_exp_f32 v23, v47
    v_cvt_pk_bf16_f32 v30, v20, v21
    v_or3_b32 v12, v12, v27, v28
    v_add_u32 v3, s39, v3
    v_mfma_f32_32x32x16_bf16 v[48:63], a[96:99], a[60:63], v[48:63]
    v_cvt_pk_bf16_f32 v31, v22, v23
    v_or3_b32 v12, v12, v29, v30
    v_add_u32 v4, s39, v4
    v_mad_i32_i24 v5, v8, s39, v5
    v_mad_i32_i24 v6, v8, s39, v6
    v_mfma_f32_32x32x16_bf16 v[48:63], a[100:103], a[64:67], v[48:63]
    v_or3_b32 v12, v12, v31, s42
    v_and_b32 v12, 0x40004000, v12
    v_cmp_ne_u32 vcc, 0, v12
    s_cmp_gt_u32 s30, 3
    s_cselect_b32 s47, s31, s34
    v_mfma_f32_32x32x16_bf16 v[48:63], a[104:107], a[68:71], v[48:63]
    s_cselect_b32 s34, s34, s35
    s_cselect_b32 s35, s35, s36
    s_waitcnt vmcnt(9) lgkmcnt(0)
    s_cbranch_vccnz L3_rare0
L3_back0:
    s_cmp_eq_u32 s30, s61
    s_cbranch_scc1 L3_chk
L3_chkb:
    v_mfma_f32_32x32x16_bf16 v[96:111], a[108:111], v[24:27], v[96:111]
    ds_read_b128 a[72:75], v1 offset:0
    ds_read_b128 a[76:79], v2 offset:1024
    s_add_u32 m0, s38, 0
    v_mfma_f32_32x32x16_bf16 v[112:127], a[112:115], v[24:27], v[112:127]
    ds_read_b128 a[80:83], v1 offset:2048
    ds_read_b128 a[84:87], v2 offset:3072
    buffer_load_dwordx4 v7, s[12:15], s47 offen offset:0 sc1 lds
    v_mfma_f32_32x32x16_bf16 v[128:143], a[116:119], v[24:27], v[128:143]
    ds_read_b128 a[88:91], v1 offset:4096
    ds_read_b128 a[92:95], v2 offset:5120
    s_add_u32 s31, s31, 36864
    s_cmp_ge_u32 s31, s33
    s_cselect_b32 s31, s32, s31
    v_mfma_f32_32x32x16_bf16 v[144:159], a[120:123], v[24:27], v[144:159]
    ds_read_b128 a[96:99], v1 offset:6144
    ds_read_b128 a[100:103], v2 offset:7168
    buffer_load_dwordx4 v7, s[12:15], s47 offen offset:1024 sc1 lds
    v_mfma_f32_32x32x16_bf16 v[160:175], a[124:127], v[24:27], v[160:175]
    ds_read_b128 a[104:107], v1 offset:8192
    s_cmp_eq_u32 s50, 18432
    s_cselect_b32 s39, 4294948864, s53
    s_add_u32 s50, s50, s39
    v_mfma_f32_32x32x16_bf16 v[96:111], a[128:131], v[28:31], v[96:111]
    v_exp_f32 v16, v48
    v_exp_f32 v17, v49
    v_add_u32 v1, s39, v1
    v_add_u32 v2, s39, v2
    v_mfma_f32_32x32x16_bf16 v[112:127], a[132:135], v[28:31], v[112:127]
    v_exp_f32 v18, v50
    v_cvt_pk_bf16_f32 v24, v16, v17
    v_exp_f32 v19, v51
    v_mfma_f32_32x32x16_bf16 v[128:143], a[136:139], v[28:31], v[128:143]
    v_exp_f32 v20, v52
    v_cvt_pk_bf16_f32 v25, v18, v19
    buffer_load_dwordx4 v7, s[12:15], s47 offen offset:2048 sc1 lds
    v_mfma_f32_32x32x16_bf16 v[144:159], a[140:143], v[28:31], v[144:159]
    v_exp_f32 v21, v53
    v_exp_f32 v22, v54
    v_cvt_pk_bf16_f32 v26, v20, v21
    v_mfma_f32_32x32x16_bf16 v[160:175], a[144:147], v[28:31], v[160:175]
    v_exp_f32 v23, v55
    v_or3_b32 v12, v24, v25, v26
    s_waitcnt lgkmcnt(0)
    v_mfma_f32_32x32x16_bf16 v[32:47], a[72:75], a[0:3], v[64:79]
    v_exp_f32 v16, v56
    v_cvt_pk_bf16_f32 v27, v22, v23
    buffer_load_dwordx4 v7, s[12:15], s47 offen offset:3072 sc1 lds
    v_mfma_f32_32x32x16_bf16 v[32:47], a[76:79], a[4:7], v[32:47]
    v_exp_f32 v17, v57
    v_exp_f32 v18, v58
    s_add_u32 m0, s38, 4096
    s_add_u32 s47, s47, 4096
    v_mfma_f32_32x32x16_bf16 v[32:47], a[80:83], a[8:11], v[32:47]
    v_cvt_pk_bf16_f32 v28, v16, v17
    v_exp_f32 v19, v59
    buffer_load_dwordx4 v7, s[12:15], s47 offen offset:0 sc1 lds
    v_mfma_f32_32x32x16_bf16 v[32:47], a[84:87], a[12:15], v[32:47]
    v_exp_f32 v20, v60
    v_cvt_pk_bf16_f32 v29, v18, v19
    v_mfma_f32_32x32x16_bf16 v[32:47], a[88:91], a[16:19], v[32:47]
    v_exp_f32 v21, v61
    v_exp_f32 v22, v62
    buffer_load_dwordx4 v7, s[12:15], s47 offen offset:1024 sc1 lds
    v_mfma_f32_32x32x16_bf16 v[32:47], a[92:95], a[20:23], v[32:47]
    v_exp_f32 v23, v63
    v_cvt_pk_bf16_f32 v30, v20, v21
    v_or3_b32 v12, v12, v27, v28
    v_mfma_f32_32x32x16_bf16 v[32:47], a[96:99], a[24:27], v[32:47]
    v_cvt_pk_bf16_f32 v31, v22, v23
    v_or3_b32 v12, v12, v29, v30
    buffer_load_dwordx4 v7, s[12:15], s47 offen offset:2048 sc1 lds
    v_mfma_f32_32x32x16_bf16 v[32:47], a[100:103], a[28:31], v[32:47]
    v_or3_b32 v12, v12, v31, s43
    v_and_b32 v12, 0x40004000, v12
    v_cmp_ne_u32 vcc, 0, v12
    v_mfma_f32_32x32x16_bf16 v[32:47], a[104:107], a[32:35], v[32:47]
    s_sub_u32 s30, s30, 1
    s_cbranch_vccnz L3_rare1
L3_back1:
    v_mfma_f32_32x32x16_bf16 v[176:191], a[108:111], v[24:27], v[176:191]
    ds_read_b64_tr_b16 a[108:109], v3 offset:0
    ds_read_b64_tr_b16 a[110:111], v4 offset:0
    buffer_load_dwordx4 v7, s[12:15], s47 offen offset:3072 sc1 lds
    v_mfma_f32_32x32x16_bf16 v[192:207], a[112:115], v[24:27], v[192:207]
    ds_read_b64_tr_b16 a[112:113], v3 offset:2048
    ds_read_b64_tr_b16 a[114:115], v4 offset:2048
    s_add_u32 m0, s38, 8192
    s_add_u32 s47, s47, 4096
    v_mfma_f32_32x32x16_bf16 v[208:223], a[116:119], v[24:27], v[208:223]
    ds_read_b64_tr_b16 a[116:117], v3 offset:4096
    ds_read_b64_tr_b16 a[118:119], v4 offset:4096
    v_mfma_f32_32x32x16_bf16 v[224:239], a[120:123], v[24:27], v[224:239]
    ds_read_b64_tr_b16 a[120:121], v3 offset:6144
    ds_read_b64_tr_b16 a[122:123], v4 offset:6144
    buffer_load_dwordx4 v7, s[12:15], s47 offen offset:0 sc1 lds
    v_mfma_f32_32x32x16_bf16 v[240:255], a[124:127], v[24:27], v[240:255]
    ds_read_b64_tr_b16 a[124:125], v5 offset:0
    ds_read_b64_tr_b16 a[126:127], v6 offset:0
    v_mfma_f32_32x32x16_bf16 v[176:191], a[128:131], v[28:31], v[176:191]
    v_exp_f32 v16, v32
    v_exp_f32 v17, v33
    v_mfma_f32_32x32x16_bf16 v[192:207], a[132:135], v[28:31], v[192:207]
    v_exp_f32 v18, v34
    v_cvt_pk_bf16_f32 v24, v16, v17
    v_exp_f32 v19, v35
    v_mfma_f32_32x32x16_bf16 v[208:223], a[136:139], v[28:31], v[208:223]
    v_exp_f32 v20, v36
    v_cvt_pk_bf16_f32 v25, v18, v19
    v_mfma_f32_32x32x16_bf16 v[224:239], a[140:143], v[28:31], v[224:239]
    v_exp_f32 v21, v37
    v_exp_f32 v22, v38
    v_cvt_pk_bf16_f32 v26, v20, v21
    v_mfma_f32_32x32x16_bf16 v[240:255], a[144:147], v[28:31], v[240:255]
    v_exp_f32 v23, v39
    v_or3_b32 v12, v24, v25, v26
    s_cmp_lg_u32 s30, 0
    s_cbranch_scc1 L3_loop
    v_and_b32 v10, 31, v0
    v_lshrrev_b32 v11, 5, v0
    v_mul_u32_u24 v9, 288, v10
    v_lshl_add_u32 v9, v11, 4, v9
    s_lshl_b32 s40, s28, 6
    s_add_u32 s40, s40, s46
    buffer_load_dwordx4 v[48:51], v9, s[16:19], s40 offen
    buffer_load_dwordx4 v[52:55], v9, s[16:19], s40 offen offset:32
    buffer_load_dwordx4 v[56:59], v9, s[16:19], s40 offen offset:64
    v_add_u32 v2, 147968, v7
    s_lshl_b32 s10, s28, 10
    v_add_u32 v3, s10, v2
    v_add_u32 v1, s37, v7
    v_mov_b32 v12, v64
    v_mov_b32 v13, v168
    v_mov_b32 v14, v80
    v_mov_b32 v15, v248
    ds_write_b128 v3, v[12:15]
    s_cmp_eq_u32 s28, 3
    s_cbranch_scc0 L3_nx
    v_add_u32 v4, 154112, v7
    v_add_u32 v5, v4, v7
    s_waitcnt vmcnt(3)
    ds_read_b128 v[24:27], v4
    ds_read_b128 v[28:31], v4 offset:1024
    s_waitcnt lgkmcnt(0)
    v_lshlrev_b32 v32, 16, v24
    v_and_b32 v33, 0xffff0000, v24
    v_lshlrev_b32 v34, 16, v25
    v_and_b32 v35, 0xffff0000, v25
    v_lshlrev_b32 v36, 16, v26
    v_and_b32 v37, 0xffff0000, v26
    v_lshlrev_b32 v38, 16, v27
    v_and_b32 v39, 0xffff0000, v27
    v_lshlrev_b32 v40, 16, v28
    v_and_b32 v41, 0xffff0000, v28
    v_lshlrev_b32 v42, 16, v29
    v_and_b32 v43, 0xffff0000, v29
    v_lshlrev_b32 v44, 16, v30
    v_and_b32 v45, 0xffff0000, v30
    v_lshlrev_b32 v46, 16, v31
    v_and_b32 v47, 0xffff0000, v31
    ds_write_b128 v5, v[32:35] offset:2048
    ds_write_b128 v5, v[36:39] offset:2064
    ds_write_b128 v5, v[40:43] offset:4096
    ds_write_b128 v5, v[44:47] offset:4112
L3_nx:
    s_waitcnt vmcnt(3) lgkmcnt(0)
    s_barrier
    ds_read_b128 v[32:35], v2 offset:0
    ds_read_b128 v[36:39], v2 offset:1024
    ds_read_b128 v[40:43], v2 offset:2048
    ds_read_b128 v[44:47], v2 offset:3072
    ds_read_b128 a[0:3], v1 offset:9216
    ds_read_b128 a[4:7], v1 offset:10240
    ds_read_b128 a[8:11], v1 offset:11264
    ds_read_b128 a[12:15], v1 offset:12288
    ds_read_b128 a[16:19], v1 offset:13312
    ds_read_b128 a[20:23], v1 offset:14336
    ds_read_b128 a[24:27], v1 offset:15360
    ds_read_b128 a[28:31], v1 offset:16384
    ds_read_b128 a[32:35], v1 offset:17408
    ds_read_b128 a[36:39], v1 offset:18432
    ds_read_b128 a[40:43], v1 offset:19456
    s_waitcnt lgkmcnt(11)
    v_min3_f32 v20, v32, v36, v40
    v_min_f32 v20, v20, v44
    v_sub_f32 v32, v20, v32
    v_sub_f32 v36, v20, v36
    v_sub_f32 v40, v20, v40
    v_sub_f32 v44, v20, v44
    v_sub_f32 v16, v20, v12
    v_exp_f32 v32, v32
    v_exp_f32 v36, v36
    v_exp_f32 v40, v40
    v_exp_f32 v44, v44
    v_exp_f32 v16, v16
    v_mul_f32 v21, v32, v33
    v_fmac_f32 v21, v36, v37
    v_fmac_f32 v21, v40, v41
    v_fmac_f32 v21, v44, v45
    v_rcp_f32 v17, v21
    v_min3_f32 v22, v34, v38, v42
    v_min_f32 v22, v22, v46
    v_sub_f32 v34, v22, v34
    v_sub_f32 v38, v22, v38
    v_sub_f32 v42, v22, v42
    v_sub_f32 v46, v22, v46
    v_sub_f32 v18, v22, v14
    v_exp_f32 v34, v34
    v_exp_f32 v38, v38
    v_exp_f32 v42, v42
    v_exp_f32 v46, v46
    v_exp_f32 v18, v18
    v_mul_f32 v23, v34, v35
    v_fmac_f32 v23, v38, v39
    v_fmac_f32 v23, v42, v43
    v_fmac_f32 v23, v46, v47
    v_rcp_f32 v19, v23
    ds_read_b128 a[44:47], v1 offset:20480
    ds_read_b128 a[48:51], v1 offset:21504
    ds_read_b128 a[52:55], v1 offset:22528
    ds_read_b128 a[56:59], v1 offset:23552
    ds_read_b128 a[60:63], v1 offset:24576
    ds_read_b128 a[64:67], v1 offset:25600
    ds_read_b128 a[68:71], v1 offset:26624
    v_mul_f32 v16, v16, v17
    v_mul_f32 v18, v18, v19
    s_lshl_b32 s11, s28, 11
    s_add_u32 s11, s11, 55296
    v_add_u32 v2, s11, v7
    s_and_b32 s11, s28, 1
    s_lshl_b32 s11, s11, 3
    s_cmp_ge_u32 s28, 2
    s_cselect_b32 s54, 19456, 0
    s_add_u32 s11, s11, s54
    v_add_u32 v3, s11, v7
    ds_write_b128 v2, a[220:223]
    ds_write_b128 v2, a[224:227] offset:1024
    ds_write_b128 v2, a[228:231] offset:28672
    ds_write_b128 v2, a[232:235] offset:29696
    ds_write_b64 v3, a[236:237] offset:63488
    s_mul_i32 s11, s28, 9216
    s_add_u32 s11, s11, 110592
    v_add_u32 v2, s11, v7
    v_pk_mul_f32 v[96:97], v[96:97], v[16:17] op_sel_hi:[1,0]
    v_pk_mul_f32 v[98:99], v[98:99], v[16:17] op_sel_hi:[1,0]
    v_pk_mul_f32 v[100:101], v[100:101], v[16:17] op_sel_hi:[1,0]
    v_pk_mul_f32 v[102:103], v[102:103], v[16:17] op_sel_hi:[1,0]
    v_cvt_pk_f16_f32 v96, v96, v97
    v_cvt_pk_f16_f32 v97, v98, v99
    v_cvt_pk_f16_f32 v98, v100, v101
    v_cvt_pk_f16_f32 v99, v102, v103
    ds_write_b128 v2, v[96:99] offset:0
    v_pk_mul_f32 v[104:105], v[104:105], v[16:17] op_sel_hi:[1,0]
    v_pk_mul_f32 v[106:107], v[106:107], v[16:17] op_sel_hi:[1,0]
    v_pk_mul_f32 v[108:109], v[108:109], v[16:17] op_sel_hi:[1,0]
    v_pk_mul_f32 v[110:111], v[110:111], v[16:17] op_sel_hi:[1,0]
    v_cvt_pk_f16_f32 v104, v104, v105
    v_cvt_pk_f16_f32 v105, v106, v107
    v_cvt_pk_f16_f32 v106, v108, v109
    v_cvt_pk_f16_f32 v107, v110, v111
    ds_write_b128 v2, v[104:107] offset:1024
    v_pk_mul_f32 v[112:113], v[112:113], v[16:17] op_sel_hi:[1,0]
    v_pk_mul_f32 v[114:115], v[114:115], v[16:17] op_sel_hi:[1,0]
    v_pk_mul_f32 v[116:117], v[116:117], v[16:17] op_sel_hi:[1,0]
    v_pk_mul_f32 v[118:119], v[118:119], v[16:17] op_sel_hi:[1,0]
    v_cvt_pk_f16_f32 v112, v112, v113
    v_cvt_pk_f16_f32 v113, v114, v115
    v_cvt_pk_f16_f32 v114, v116, v117
    v_cvt_pk_f16_f32 v115, v118, v119
    ds_write_b128 v2, v[112:115] offset:2048
    v_pk_mul_f32 v[120:121], v[120:121], v[16:17] op_sel_hi:[1,0]
    v_pk_mul_f32 v[122:123], v[122:123], v[16:17] op_sel_hi:[1,0]
    v_pk_mul_f32 v[124:125], v[124:125], v[16:17] op_sel_hi:[1,0]
    v_pk_mul_f32 v[126:127], v[126:127], v[16:17] op_sel_hi:[1,0]
    v_cvt_pk_f16_f32 v120, v120, v121
    v_cvt_pk_f16_f32 v121, v122, v123
    v_cvt_pk_f16_f32 v122, v124, v125
    v_cvt_pk_f16_f32 v123, v126, v127
    ds_write_b128 v2, v[120:123] offset:3072
    v_pk_mul_f32 v[128:129], v[128:129], v[16:17] op_sel_hi:[1,0]
    v_pk_mul_f32 v[130:131], v[130:131], v[16:17] op_sel_hi:[1,0]
    v_pk_mul_f32 v[132:133], v[132:133], v[16:17] op_sel_hi:[1,0]
    v_pk_mul_f32 v[134:135], v[134:135], v[16:17] op_sel_hi:[1,0]
    v_cvt_pk_f16_f32 v128, v128, v129
    v_cvt_pk_f16_f32 v129, v130, v131
    v_cvt_pk_f16_f32 v130, v132, v133
    v_cvt_pk_f16_f32 v131, v134, v135
    ds_write_b128 v2, v[128:131] offset:4096
    v_pk_mul_f32 v[136:137], v[136:137], v[16:17] op_sel_hi:[1,0]
    v_pk_mul_f32 v[138:139], v[138:139], v[16:17] op_sel_hi:[1,0]
    v_pk_mul_f32 v[140:141], v[140:141], v[16:17] op_sel_hi:[1,0]
    v_pk_mul_f32 v[142:143], v[142:143], v[16:17] op_sel_hi:[1,0]
    v_cvt_pk_f16_f32 v136, v136, v137
    v_cvt_pk_f16_f32 v137, v138, v139
    v_cvt_pk_f16_f32 v138, v140, v141
    v_cvt_pk_f16_f32 v139, v142, v143
    ds_write_b128 v2, v[136:139] offset:5120
    v_pk_mul_f32 v[144:145], v[144:145], v[16:17] op_sel_hi:[1,0]
    v_pk_mul_f32 v[146:147], v[146:147], v[16:17] op_sel_hi:[1,0]
    v_pk_mul_f32 v[148:149], v[148:149], v[16:17] op_sel_hi:[1,0]
    v_pk_mul_f32 v[150:151], v[150:151], v[16:17] op_sel_hi:[1,0]
    v_cvt_pk_f16_f32 v144, v144, v145
    v_cvt_pk_f16_f32 v145, v146, v147
    v_cvt_pk_f16_f32 v146, v148, v149
    v_cvt_pk_f16_f32 v147, v150, v151
    ds_write_b128 v2, v[144:147] offset:6144
    v_pk_mul_f32 v[152:153], v[152:153], v[16:17] op_sel_hi:[1,0]
    v_pk_mul_f32 v[154:155], v[154:155], v[16:17] op_sel_hi:[1,0]
    v_pk_mul_f32 v[156:157], v[156:157], v[16:17] op_sel_hi:[1,0]
    v_pk_mul_f32 v[158:159], v[158:159], v[16:17] op_sel_hi:[1,0]
    v_cvt_pk_f16_f32 v152, v152, v153
    v_cvt_pk_f16_f32 v153, v154, v155
    v_cvt_pk_f16_f32 v154, v156, v157
    v_cvt_pk_f16_f32 v155, v158, v159
    ds_write_b128 v2, v[152:155] offset:7168
    v_pk_mul_f32 v[160:161], v[160:161], v[16:17] op_sel_hi:[1,0]
    v_pk_mul_f32 v[162:163], v[162:163], v[16:17] op_sel_hi:[1,0]
    v_pk_mul_f32 v[164:165], v[164:165], v[16:17] op_sel_hi:[1,0]
    v_pk_mul_f32 v[166:167], v[166:167], v[16:17] op_sel_hi:[1,0]
    v_cvt_pk_f16_f32 v160, v160, v161
    v_cvt_pk_f16_f32 v161, v162, v163
    v_cvt_pk_f16_f32 v162, v164, v165
    v_cvt_pk_f16_f32 v163, v166, v167
    ds_write_b128 v2, v[160:163] offset:8192
    s_add_u32 s11, s10, 110592
    v_add_u32 v3, s11, v7
    v_add_u32 v4, 18432, v3
    s_lshl_b32 s54, s28, 2
    s_add_u32 s11, s54, 118784
    v_add_u32 v5, s11, v7
    v_add_u32 v6, 18432, v5
    s_xor_b32 s11, s2, 2
    s_mul_i32 s11, s11, 12288
    s_mul_i32 s55, s28, 3072
    s_add_u32 s55, s55, 7050240
    s_add_u32 s11, s11, s55
    s_waitcnt lgkmcnt(0)
    s_barrier
    ds_read_b128 v[96:99], v3 offset:0
    ds_read_b128 v[100:103], v3 offset:4096
    ds_read_b32 v104, v5 offset:0
    ds_read_b128 v[108:111], v3 offset:9216
    ds_read_b128 v[112:115], v3 offset:13312
    ds_read_b32 v116, v5 offset:9216
    ds_read_b128 v[120:123], v4 offset:0
    ds_read_b128 v[124:127], v4 offset:4096
    ds_read_b32 v128, v6 offset:0
    ds_read_b128 v[132:135], v4 offset:9216
    ds_read_b128 v[136:139], v4 offset:13312
    ds_read_b32 v140, v6 offset:9216
    s_waitcnt lgkmcnt(6)
    v_pk_add_f16 v96, v96, v108
    v_pk_add_f16 v97, v97, v109
    v_pk_add_f16 v98, v98, v110
    v_pk_add_f16 v99, v99, v111
    v_pk_add_f16 v100, v100, v112
    v_pk_add_f16 v101, v101, v113
    v_pk_add_f16 v102, v102, v114
    v_pk_add_f16 v103, v103, v115
    v_pk_add_f16 v104, v104, v116
    s_waitcnt lgkmcnt(0)
    v_pk_add_f16 v120, v120, v132
    v_pk_add_f16 v121, v121, v133
    v_pk_add_f16 v122, v122, v134
    v_pk_add_f16 v123, v123, v135
    v_pk_add_f16 v124, v124, v136
    v_pk_add_f16 v125, v125, v137
    v_pk_add_f16 v126, v126, v138
    v_pk_add_f16 v127, v127, v139
    v_pk_add_f16 v128, v128, v140
    v_pk_add_f16 v96, v96, v120
    v_pk_add_f16 v97, v97, v121
    v_pk_add_f16 v98, v98, v122
    v_pk_add_f16 v99, v99, v123
    v_pk_add_f16 v100, v100, v124
    v_pk_add_f16 v101, v101, v125
    v_pk_add_f16 v102, v102, v126
    v_pk_add_f16 v103, v103, v127
    v_pk_add_f16 v104, v104, v128
    v_mov_b32 v105, v20
    v_mov_b32 v106, v21
    v_mov_b32 v107, 0
    buffer_store_dwordx4 v[96:99], v7, s[12:15], s11 offen sc1
    buffer_store_dwordx4 v[100:103], v7, s[12:15], s11 offen offset:1024 sc1
    buffer_store_dwordx4 v[104:107], v7, s[12:15], s11 offen offset:2048 sc1
    s_cmp_ge_u32 s2, 250
    s_cbranch_scc1 L3_exit
    s_mul_i32 s57, s28, 3
    v_lshlrev_b32 v12, 9, v11
    v_lshl_add_u32 v12, v10, 4, v12
    v_add_u32 v12, 82912, v12
    v_lshlrev_b32 v13, 6, v11
    v_lshl_add_u32 v13, v10, 4, v13
    v_add_u32 v13, 152064, v13
    v_mov_b32 v14, 1024
    v_mov_b32 v15, 128
    v_cmp_gt_u32 vcc, 2, v10
    v_add_u32 v24, 0, v12
    v_add_u32 v40, 0, v13
    v_cndmask_b32 v24, v24, v40, vcc
    v_cndmask_b32 v32, v14, v15, vcc
    v_mad_u32_u24 v24, v32, s57, v24
    v_cmp_gt_u32 vcc, 1, v10
    v_add_u32 v25, 16, v12
    v_add_u32 v40, 16, v13
    v_cndmask_b32 v25, v25, v40, vcc
    v_cndmask_b32 v33, v14, v15, vcc
    v_mad_u32_u24 v25, v33, s57, v25
    v_add_u32 v26, 32, v12
    v_mov_b32 v34, v14
    v_mad_u32_u24 v26, v34, s57, v26
    v_cmp_lt_u32 vcc, 30, v10
    v_add_u32 v27, 48, v12
    v_add_u32 v40, 4294966832, v13
    v_cndmask_b32 v27, v27, v40, vcc
    v_cndmask_b32 v35, v14, v15, vcc
    v_mad_u32_u24 v27, v35, s57, v27
    v_cmp_lt_u32 vcc, 29, v10
    v_add_u32 v28, 64, v12
    v_add_u32 v40, 4294966848, v13
    v_cndmask_b32 v28, v28, v40, vcc
    v_cndmask_b32 v36, v14, v15, vcc
    v_mad_u32_u24 v28, v36, s57, v28
    s_mul_i32 s58, s28, 192
    s_add_u32 s58, s58, 156160
    v_lshl_add_u32 v29, v11, 5, s58
    s_mul_i32 s58, s28, 3072
    v_add_u32 v30, s58, v7
    v_add_u32 v31, 55296, v30
    ds_read_b128 v[112:115], v24
    ds_read_b128 v[132:135], v29 offset:0
    ds_read_b128 v[136:139], v29 offset:16
    ds_read_b128 v[116:119], v25
    ds_read_b128 v[140:143], v29 offset:576
    ds_read_b128 v[144:147], v29 offset:592
    ds_read_b128 v[120:123], v26
    ds_read_b128 v[148:151], v29 offset:1152
    ds_read_b128 v[152:155], v29 offset:1168
    ds_read_b128 v[124:127], v27
    ds_read_b128 v[156:159], v29 offset:1728
    ds_read_b128 v[160:163], v29 offset:1744
    ds_read_b128 v[128:131], v28
    ds_read_b128 v[164:167], v29 offset:2304
    ds_read_b128 v[168:171], v29 offset:2320
    ds_read_b128 v[172:175], v31 offset:0
    v_add_u32 v24, v24, v32
    v_add_u32 v25, v25, v33
    v_add_u32 v26, v26, v34
    v_add_u32 v27, v27, v35
    v_add_u32 v28, v28, v36
    v_pk_mul_f32 v[176:177], v[176:177], v[18:19] op_sel_hi:[1,0]
    v_pk_mul_f32 v[178:179], v[178:179], v[18:19] op_sel_hi:[1,0]
    v_pk_mul_f32 v[180:181], v[180:181], v[18:19] op_sel_hi:[1,0]
    v_pk_mul_f32 v[182:183], v[182:183], v[18:19] op_sel_hi:[1,0]
    v_cvt_pk_f16_f32 v176, v176, v177
    v_cvt_pk_f16_f32 v177, v178, v179
    v_cvt_pk_f16_f32 v178, v180, v181
    v_cvt_pk_f16_f32 v179, v182, v183
    ds_write_b128 v1, v[176:179] offset:9216
    v_pk_mul_f32 v[184:185], v[184:185], v[18:19] op_sel_hi:[1,0]
    v_pk_mul_f32 v[186:187], v[186:187], v[18:19] op_sel_hi:[1,0]
    v_pk_mul_f32 v[188:189], v[188:189], v[18:19] op_sel_hi:[1,0]
    v_pk_mul_f32 v[190:191], v[190:191], v[18:19] op_sel_hi:[1,0]
    v_cvt_pk_f16_f32 v184, v184, v185
    v_cvt_pk_f16_f32 v185, v186, v187
    v_cvt_pk_f16_f32 v186, v188, v189
    v_cvt_pk_f16_f32 v187, v190, v191
    ds_write_b128 v1, v[184:187] offset:10240
    v_pk_mul_f32 v[192:193], v[192:193], v[18:19] op_sel_hi:[1,0]
    v_pk_mul_f32 v[194:195], v[194:195], v[18:19] op_sel_hi:[1,0]
    v_pk_mul_f32 v[196:197], v[196:197], v[18:19] op_sel_hi:[1,0]
    v_pk_mul_f32 v[198:199], v[198:199], v[18:19] op_sel_hi:[1,0]
    v_cvt_pk_f16_f32 v192, v192, v193
    v_cvt_pk_f16_f32 v193, v194, v195
    v_cvt_pk_f16_f32 v194, v196, v197
    v_cvt_pk_f16_f32 v195, v198, v199
    ds_write_b128 v1, v[192:195] offset:11264
    v_pk_mul_f32 v[200:201], v[200:201], v[18:19] op_sel_hi:[1,0]
    v_pk_mul_f32 v[202:203], v[202:203], v[18:19] op_sel_hi:[1,0]
    v_pk_mul_f32 v[204:205], v[204:205], v[18:19] op_sel_hi:[1,0]
    v_pk_mul_f32 v[206:207], v[206:207], v[18:19] op_sel_hi:[1,0]
    v_cvt_pk_f16_f32 v200, v200, v201
    v_cvt_pk_f16_f32 v201, v202, v203
    v_cvt_pk_f16_f32 v202, v204, v205
    v_cvt_pk_f16_f32 v203, v206, v207
    ds_write_b128 v1, v[200:203] offset:12288
    v_pk_mul_f32 v[208:209], v[208:209], v[18:19] op_sel_hi:[1,0]
    v_pk_mul_f32 v[210:211], v[210:211], v[18:19] op_sel_hi:[1,0]
    v_pk_mul_f32 v[212:213], v[212:213], v[18:19] op_sel_hi:[1,0]
    v_pk_mul_f32 v[214:215], v[214:215], v[18:19] op_sel_hi:[1,0]
    v_cvt_pk_f16_f32 v208, v208, v209
    v_cvt_pk_f16_f32 v209, v210, v211
    v_cvt_pk_f16_f32 v210, v212, v213
    v_cvt_pk_f16_f32 v211, v214, v215
    ds_write_b128 v1, v[208:211] offset:13312
    v_pk_mul_f32 v[216:217], v[216:217], v[18:19] op_sel_hi:[1,0]
    v_pk_mul_f32 v[218:219], v[218:219], v[18:19] op_sel_hi:[1,0]
    v_pk_mul_f32 v[220:221], v[220:221], v[18:19] op_sel_hi:[1,0]
    v_pk_mul_f32 v[222:223], v[222:223], v[18:19] op_sel_hi:[1,0]
    v_cvt_pk_f16_f32 v216, v216, v217
    v_cvt_pk_f16_f32 v217, v218, v219
    v_cvt_pk_f16_f32 v218, v220, v221
    v_cvt_pk_f16_f32 v219, v222, v223
    ds_write_b128 v1, v[216:219] offset:14336
    v_pk_mul_f32 v[224:225], v[224:225], v[18:19] op_sel_hi:[1,0]
    v_pk_mul_f32 v[226:227], v[226:227], v[18:19] op_sel_hi:[1,0]
    v_pk_mul_f32 v[228:229], v[228:229], v[18:19] op_sel_hi:[1,0]
    v_pk_mul_f32 v[230:231], v[230:231], v[18:19] op_sel_hi:[1,0]
    v_cvt_pk_f16_f32 v224, v224, v225
    v_cvt_pk_f16_f32 v225, v226, v227
    v_cvt_pk_f16_f32 v226, v228, v229
    v_cvt_pk_f16_f32 v227, v230, v231
    ds_write_b128 v1, v[224:227] offset:15360
    v_pk_mul_f32 v[232:233], v[232:233], v[18:19] op_sel_hi:[1,0]
    v_pk_mul_f32 v[234:235], v[234:235], v[18:19] op_sel_hi:[1,0]
    v_pk_mul_f32 v[236:237], v[236:237], v[18:19] op_sel_hi:[1,0]
    v_pk_mul_f32 v[238:239], v[238:239], v[18:19] op_sel_hi:[1,0]
    v_cvt_pk_f16_f32 v232, v232, v233
    v_cvt_pk_f16_f32 v233, v234, v235
    v_cvt_pk_f16_f32 v234, v236, v237
    v_cvt_pk_f16_f32 v235, v238, v239
    ds_write_b128 v1, v[232:235] offset:16384
    v_pk_mul_f32 v[240:241], v[240:241], v[18:19] op_sel_hi:[1,0]
    v_pk_mul_f32 v[242:243], v[242:243], v[18:19] op_sel_hi:[1,0]
    v_pk_mul_f32 v[244:245], v[244:245], v[18:19] op_sel_hi:[1,0]
    v_pk_mul_f32 v[246:247], v[246:247], v[18:19] op_sel_hi:[1,0]
    v_cvt_pk_f16_f32 v240, v240, v241
    v_cvt_pk_f16_f32 v241, v242, v243
    v_cvt_pk_f16_f32 v242, v244, v245
    v_cvt_pk_f16_f32 v243, v246, v247
    ds_write_b128 v1, v[240:243] offset:17408
    s_cmp_eq_u32 s28, 3
    s_cbranch_scc1 L3_w3
    ds_read_b128 v[176:179], v24
    ds_read_b128 v[196:199], v29 offset:64
    ds_read_b128 v[200:203], v29 offset:80
    ds_read_b128 v[180:183], v25
    ds_read_b128 v[204:207], v29 offset:640
    ds_read_b128 v[208:211], v29 offset:656
    ds_read_b128 v[184:187], v26
    ds_read_b128 v[212:215], v29 offset:1216
    ds_read_b128 v[216:219], v29 offset:1232
    ds_read_b128 v[188:191], v27
    ds_read_b128 v[220:223], v29 offset:1792
    ds_read_b128 v[224:227], v29 offset:1808
    ds_read_b128 v[192:195], v28
    ds_read_b128 v[228:231], v29 offset:2368
    ds_read_b128 v[232:235], v29 offset:2384
    ds_read_b128 v[236:239], v31 offset:1024
    v_add_u32 v24, v24, v32
    v_add_u32 v25, v25, v33
    v_add_u32 v26, v26, v34
    v_add_u32 v27, v27, v35
    v_add_u32 v28, v28, v36
    s_waitcnt lgkmcnt(15)
    v_fma_mix_f32 v64, v112, v132, 0 op_sel_hi:[1,0,0]
    v_fma_mix_f32 v65, v112, v133, 0 op_sel:[1,0,0] op_sel_hi:[1,0,0]
    v_fma_mix_f32 v66, v113, v134, 0 op_sel_hi:[1,0,0]
    v_fma_mix_f32 v67, v113, v135, 0 op_sel:[1,0,0] op_sel_hi:[1,0,0]
    v_fma_mix_f32 v68, v114, v136, 0 op_sel_hi:[1,0,0]
    v_fma_mix_f32 v69, v114, v137, 0 op_sel:[1,0,0] op_sel_hi:[1,0,0]
    v_fma_mix_f32 v70, v115, v138, 0 op_sel_hi:[1,0,0]
    v_fma_mix_f32 v71, v115, v139, 0 op_sel:[1,0,0] op_sel_hi:[1,0,0]
    v_fma_mix_f32 v64, v116, v140, v64 op_sel_hi:[1,0,0]
    v_fma_mix_f32 v65, v116, v141, v65 op_sel:[1,0,0] op_sel_hi:[1,0,0]
    v_fma_mix_f32 v66, v117, v142, v66 op_sel_hi:[1,0,0]
    v_fma_mix_f32 v67, v117, v143, v67 op_sel:[1,0,0] op_sel_hi:[1,0,0]
    v_fma_mix_f32 v68, v118, v144, v68 op_sel_hi:[1,0,0]
    v_fma_mix_f32 v69, v118, v145, v69 op_sel:[1,0,0] op_sel_hi:[1,0,0]
    v_fma_mix_f32 v70, v119, v146, v70 op_sel_hi:[1,0,0]
    v_fma_mix_f32 v71, v119, v147, v71 op_sel:[1,0,0] op_sel_hi:[1,0,0]
    v_fma_mix_f32 v64, v120, v148, v64 op_sel_hi:[1,0,0]
    v_fma_mix_f32 v65, v120, v149, v65 op_sel:[1,0,0] op_sel_hi:[1,0,0]
    v_fma_mix_f32 v66, v121, v150, v66 op_sel_hi:[1,0,0]
    v_fma_mix_f32 v67, v121, v151, v67 op_sel:[1,0,0] op_sel_hi:[1,0,0]
    v_fma_mix_f32 v68, v122, v152, v68 op_sel_hi:[1,0,0]
    v_fma_mix_f32 v69, v122, v153, v69 op_sel:[1,0,0] op_sel_hi:[1,0,0]
    v_fma_mix_f32 v70, v123, v154, v70 op_sel_hi:[1,0,0]
    v_fma_mix_f32 v71, v123, v155, v71 op_sel:[1,0,0] op_sel_hi:[1,0,0]
    v_fma_mix_f32 v64, v124, v156, v64 op_sel_hi:[1,0,0]
    v_fma_mix_f32 v65, v124, v157, v65 op_sel:[1,0,0] op_sel_hi:[1,0,0]
    v_fma_mix_f32 v66, v125, v158, v66 op_sel_hi:[1,0,0]
    v_fma_mix_f32 v67, v125, v159, v67 op_sel:[1,0,0] op_sel_hi:[1,0,0]
    v_fma_mix_f32 v68, v126, v160, v68 op_sel_hi:[1,0,0]
    v_fma_mix_f32 v69, v126, v161, v69 op_sel:[1,0,0] op_sel_hi:[1,0,0]
    v_fma_mix_f32 v70, v127, v162, v70 op_sel_hi:[1,0,0]
    v_fma_mix_f32 v71, v127, v163, v71 op_sel:[1,0,0] op_sel_hi:[1,0,0]
    v_fma_mix_f32 v64, v128, v164, v64 op_sel_hi:[1,0,0]
    v_fma_mix_f32 v65, v128, v165, v65 op_sel:[1,0,0] op_sel_hi:[1,0,0]
    v_fma_mix_f32 v66, v129, v166, v66 op_sel_hi:[1,0,0]
    v_fma_mix_f32 v67, v129, v167, v67 op_sel:[1,0,0] op_sel_hi:[1,0,0]
    v_fma_mix_f32 v68, v130, v168, v68 op_sel_hi:[1,0,0]
    v_fma_mix_f32 v69, v130, v169, v69 op_sel:[1,0,0] op_sel_hi:[1,0,0]
    v_fma_mix_f32 v70, v131, v170, v70 op_sel_hi:[1,0,0]
    v_fma_mix_f32 v71, v131, v171, v71 op_sel:[1,0,0] op_sel_hi:[1,0,0]
    v_lshlrev_b32 v12, 16, v172
    v_and_b32 v13, 0xffff0000, v172
    v_pk_mul_f32 v[12:13], v[12:13], v[64:65]
    v_cvt_pk_bf16_f32 v72, v12, v13
    v_lshlrev_b32 v12, 16, v173
    v_and_b32 v13, 0xffff0000, v173
    v_pk_mul_f32 v[12:13], v[12:13], v[66:67]
    v_cvt_pk_bf16_f32 v73, v12, v13
    v_lshlrev_b32 v12, 16, v174
    v_and_b32 v13, 0xffff0000, v174
    v_pk_mul_f32 v[12:13], v[12:13], v[68:69]
    v_cvt_pk_bf16_f32 v74, v12, v13
    v_lshlrev_b32 v12, 16, v175
    v_and_b32 v13, 0xffff0000, v175
    v_pk_mul_f32 v[12:13], v[12:13], v[70:71]
    v_cvt_pk_bf16_f32 v75, v12, v13
    ds_write_b128 v30, v[72:75] offset:18432
    ds_read_b128 v[112:115], v24
    ds_read_b128 v[132:135], v29 offset:128
    ds_read_b128 v[136:139], v29 offset:144
    ds_read_b128 v[116:119], v25
    ds_read_b128 v[140:143], v29 offset:704
    ds_read_b128 v[144:147], v29 offset:720
    ds_read_b128 v[120:123], v26
    ds_read_b128 v[148:151], v29 offset:1280
    ds_read_b128 v[152:155], v29 offset:1296
    ds_read_b128 v[124:127], v27
    ds_read_b128 v[156:159], v29 offset:1856
    ds_read_b128 v[160:163], v29 offset:1872
    ds_read_b128 v[128:131], v28
    ds_read_b128 v[164:167], v29 offset:2432
    ds_read_b128 v[168:171], v29 offset:2448
    ds_read_b128 v[172:175], v31 offset:2048
    s_waitcnt lgkmcnt(15)
    v_fma_mix_f32 v64, v176, v196, 0 op_sel_hi:[1,0,0]
    v_fma_mix_f32 v65, v176, v197, 0 op_sel:[1,0,0] op_sel_hi:[1,0,0]
    v_fma_mix_f32 v66, v177, v198, 0 op_sel_hi:[1,0,0]
    v_fma_mix_f32 v67, v177, v199, 0 op_sel:[1,0,0] op_sel_hi:[1,0,0]
    v_fma_mix_f32 v68, v178, v200, 0 op_sel_hi:[1,0,0]
    v_fma_mix_f32 v69, v178, v201, 0 op_sel:[1,0,0] op_sel_hi:[1,0,0]
    v_fma_mix_f32 v70, v179, v202, 0 op_sel_hi:[1,0,0]
    v_fma_mix_f32 v71, v179, v203, 0 op_sel:[1,0,0] op_sel_hi:[1,0,0]
    v_fma_mix_f32 v64, v180, v204, v64 op_sel_hi:[1,0,0]
    v_fma_mix_f32 v65, v180, v205, v65 op_sel:[1,0,0] op_sel_hi:[1,0,0]
    v_fma_mix_f32 v66, v181, v206, v66 op_sel_hi:[1,0,0]
    v_fma_mix_f32 v67, v181, v207, v67 op_sel:[1,0,0] op_sel_hi:[1,0,0]
    v_fma_mix_f32 v68, v182, v208, v68 op_sel_hi:[1,0,0]
    v_fma_mix_f32 v69, v182, v209, v69 op_sel:[1,0,0] op_sel_hi:[1,0,0]
    v_fma_mix_f32 v70, v183, v210, v70 op_sel_hi:[1,0,0]
    v_fma_mix_f32 v71, v183, v211, v71 op_sel:[1,0,0] op_sel_hi:[1,0,0]
    v_fma_mix_f32 v64, v184, v212, v64 op_sel_hi:[1,0,0]
    v_fma_mix_f32 v65, v184, v213, v65 op_sel:[1,0,0] op_sel_hi:[1,0,0]
    v_fma_mix_f32 v66, v185, v214, v66 op_sel_hi:[1,0,0]
    v_fma_mix_f32 v67, v185, v215, v67 op_sel:[1,0,0] op_sel_hi:[1,0,0]
    v_fma_mix_f32 v68, v186, v216, v68 op_sel_hi:[1,0,0]
    v_fma_mix_f32 v69, v186, v217, v69 op_sel:[1,0,0] op_sel_hi:[1,0,0]
    v_fma_mix_f32 v70, v187, v218, v70 op_sel_hi:[1,0,0]
    v_fma_mix_f32 v71, v187, v219, v71 op_sel:[1,0,0] op_sel_hi:[1,0,0]
    v_fma_mix_f32 v64, v188, v220, v64 op_sel_hi:[1,0,0]
    v_fma_mix_f32 v65, v188, v221, v65 op_sel:[1,0,0] op_sel_hi:[1,0,0]
    v_fma_mix_f32 v66, v189, v222, v66 op_sel_hi:[1,0,0]
    v_fma_mix_f32 v67, v189, v223, v67 op_sel:[1,0,0] op_sel_hi:[1,0,0]
    v_fma_mix_f32 v68, v190, v224, v68 op_sel_hi:[1,0,0]
    v_fma_mix_f32 v69, v190, v225, v69 op_sel:[1,0,0] op_sel_hi:[1,0,0]
    v_fma_mix_f32 v70, v191, v226, v70 op_sel_hi:[1,0,0]
    v_fma_mix_f32 v71, v191, v227, v71 op_sel:[1,0,0] op_sel_hi:[1,0,0]
    v_fma_mix_f32 v64, v192, v228, v64 op_sel_hi:[1,0,0]
    v_fma_mix_f32 v65, v192, v229, v65 op_sel:[1,0,0] op_sel_hi:[1,0,0]
    v_fma_mix_f32 v66, v193, v230, v66 op_sel_hi:[1,0,0]
    v_fma_mix_f32 v67, v193, v231, v67 op_sel:[1,0,0] op_sel_hi:[1,0,0]
    v_fma_mix_f32 v68, v194, v232, v68 op_sel_hi:[1,0,0]
    v_fma_mix_f32 v69, v194, v233, v69 op_sel:[1,0,0] op_sel_hi:[1,0,0]
    v_fma_mix_f32 v70, v195, v234, v70 op_sel_hi:[1,0,0]
    v_fma_mix_f32 v71, v195, v235, v71 op_sel:[1,0,0] op_sel_hi:[1,0,0]
    v_lshlrev_b32 v12, 16, v236
    v_and_b32 v13, 0xffff0000, v236
    v_pk_mul_f32 v[12:13], v[12:13], v[64:65]
    v_cvt_pk_bf16_f32 v76, v12, v13
    v_lshlrev_b32 v12, 16, v237
    v_and_b32 v13, 0xffff0000, v237
    v_pk_mul_f32 v[12:13], v[12:13], v[66:67]
    v_cvt_pk_bf16_f32 v77, v12, v13
    v_lshlrev_b32 v12, 16, v238
    v_and_b32 v13, 0xffff0000, v238
    v_pk_mul_f32 v[12:13], v[12:13], v[68:69]
    v_cvt_pk_bf16_f32 v78, v12, v13
    v_lshlrev_b32 v12, 16, v239
    v_and_b32 v13, 0xffff0000, v239
    v_pk_mul_f32 v[12:13], v[12:13], v[70:71]
    v_cvt_pk_bf16_f32 v79, v12, v13
    ds_write_b128 v30, v[76:79] offset:19456
    s_waitcnt lgkmcnt(1)
    v_fma_mix_f32 v64, v112, v132, 0 op_sel_hi:[1,0,0]
    v_fma_mix_f32 v65, v112, v133, 0 op_sel:[1,0,0] op_sel_hi:[1,0,0]
    v_fma_mix_f32 v66, v113, v134, 0 op_sel_hi:[1,0,0]
    v_fma_mix_f32 v67, v113, v135, 0 op_sel:[1,0,0] op_sel_hi:[1,0,0]
    v_fma_mix_f32 v68, v114, v136, 0 op_sel_hi:[1,0,0]
    v_fma_mix_f32 v69, v114, v137, 0 op_sel:[1,0,0] op_sel_hi:[1,0,0]
    v_fma_mix_f32 v70, v115, v138, 0 op_sel_hi:[1,0,0]
    v_fma_mix_f32 v71, v115, v139, 0 op_sel:[1,0,0] op_sel_hi:[1,0,0]
    v_fma_mix_f32 v64, v116, v140, v64 op_sel_hi:[1,0,0]
    v_fma_mix_f32 v65, v116, v141, v65 op_sel:[1,0,0] op_sel_hi:[1,0,0]
    v_fma_mix_f32 v66, v117, v142, v66 op_sel_hi:[1,0,0]
    v_fma_mix_f32 v67, v117, v143, v67 op_sel:[1,0,0] op_sel_hi:[1,0,0]
    v_fma_mix_f32 v68, v118, v144, v68 op_sel_hi:[1,0,0]
    v_fma_mix_f32 v69, v118, v145, v69 op_sel:[1,0,0] op_sel_hi:[1,0,0]
    v_fma_mix_f32 v70, v119, v146, v70 op_sel_hi:[1,0,0]
    v_fma_mix_f32 v71, v119, v147, v71 op_sel:[1,0,0] op_sel_hi:[1,0,0]
    v_fma_mix_f32 v64, v120, v148, v64 op_sel_hi:[1,0,0]
    v_fma_mix_f32 v65, v120, v149, v65 op_sel:[1,0,0] op_sel_hi:[1,0,0]
    v_fma_mix_f32 v66, v121, v150, v66 op_sel_hi:[1,0,0]
    v_fma_mix_f32 v67, v121, v151, v67 op_sel:[1,0,0] op_sel_hi:[1,0,0]
    v_fma_mix_f32 v68, v122, v152, v68 op_sel_hi:[1,0,0]
    v_fma_mix_f32 v69, v122, v153, v69 op_sel:[1,0,0] op_sel_hi:[1,0,0]
    v_fma_mix_f32 v70, v123, v154, v70 op_sel_hi:[1,0,0]
    v_fma_mix_f32 v71, v123, v155, v71 op_sel:[1,0,0] op_sel_hi:[1,0,0]
    v_fma_mix_f32 v64, v124, v156, v64 op_sel_hi:[1,0,0]
    v_fma_mix_f32 v65, v124, v157, v65 op_sel:[1,0,0] op_sel_hi:[1,0,0]
    v_fma_mix_f32 v66, v125, v158, v66 op_sel_hi:[1,0,0]
    v_fma_mix_f32 v67, v125, v159, v67 op_sel:[1,0,0] op_sel_hi:[1,0,0]
    v_fma_mix_f32 v68, v126, v160, v68 op_sel_hi:[1,0,0]
    v_fma_mix_f32 v69, v126, v161, v69 op_sel:[1,0,0] op_sel_hi:[1,0,0]
    v_fma_mix_f32 v70, v127, v162, v70 op_sel_hi:[1,0,0]
    v_fma_mix_f32 v71, v127, v163, v71 op_sel:[1,0,0] op_sel_hi:[1,0,0]
    v_fma_mix_f32 v64, v128, v164, v64 op_sel_hi:[1,0,0]
    v_fma_mix_f32 v65, v128, v165, v65 op_sel:[1,0,0] op_sel_hi:[1,0,0]
    v_fma_mix_f32 v66, v129, v166, v66 op_sel_hi:[1,0,0]
    v_fma_mix_f32 v67, v129, v167, v67 op_sel:[1,0,0] op_sel_hi:[1,0,0]
    v_fma_mix_f32 v68, v130, v168, v68 op_sel_hi:[1,0,0]
    v_fma_mix_f32 v69, v130, v169, v69 op_sel:[1,0,0] op_sel_hi:[1,0,0]
    v_fma_mix_f32 v70, v131, v170, v70 op_sel_hi:[1,0,0]
    v_fma_mix_f32 v71, v131, v171, v71 op_sel:[1,0,0] op_sel_hi:[1,0,0]
    v_lshlrev_b32 v12, 16, v172
    v_and_b32 v13, 0xffff0000, v172
    v_pk_mul_f32 v[12:13], v[12:13], v[64:65]
    v_cvt_pk_bf16_f32 v80, v12, v13
    v_lshlrev_b32 v12, 16, v173
    v_and_b32 v13, 0xffff0000, v173
    v_pk_mul_f32 v[12:13], v[12:13], v[66:67]
    v_cvt_pk_bf16_f32 v81, v12, v13
    v_lshlrev_b32 v12, 16, v174
    v_and_b32 v13, 0xffff0000, v174
    v_pk_mul_f32 v[12:13], v[12:13], v[68:69]
    v_cvt_pk_bf16_f32 v82, v12, v13
    v_lshlrev_b32 v12, 16, v175
    v_and_b32 v13, 0xffff0000, v175
    v_pk_mul_f32 v[12:13], v[12:13], v[70:71]
    v_cvt_pk_bf16_f32 v83, v12, v13
    ds_write_b128 v30, v[80:83] offset:20480
    s_branch L3_w3d
L3_w3:
    ds_read_b128 a[72:75], v7 offset:0
    ds_read_b128 a[76:79], v7 offset:1024
    ds_read_b128 a[80:83], v7 offset:2048
    ds_read_b128 a[84:87], v7 offset:3072
    ds_read_b128 a[88:91], v7 offset:4096
    ds_read_b128 a[92:95], v7 offset:5120
    ds_read_b128 a[96:99], v7 offset:6144
    ds_read_b128 a[100:103], v7 offset:7168
    ds_read_b128 a[104:107], v7 offset:8192
    ds_read_b128 a[108:111], v7 offset:27648
    ds_read_b128 a[112:115], v7 offset:28672
    ds_read_b128 a[116:119], v7 offset:29696
    ds_read_b128 a[120:123], v7 offset:30720
    ds_read_b128 a[124:127], v7 offset:31744
    ds_read_b128 a[128:131], v7 offset:32768
    ds_read_b128 a[132:135], v7 offset:33792
    ds_read_b128 a[136:139], v7 offset:34816
    ds_read_b128 a[140:143], v7 offset:35840
L3_w3d:
    s_mul_i32 s11, s2, 12288
    s_add_u32 s11, s11, s55
    v_add_u32 v3, s10, v7
    v_add_u32 v2, 46080, v3
    v_add_u32 v3, 9216, v3
    v_add_u32 v4, 55296, v3
    s_add_u32 s54, s54, 8192
    v_add_u32 v5, s54, v7
    v_add_u32 v1, 46080, v5
    v_add_u32 v5, 9216, v5
    v_add_u32 v6, 55296, v5
    s_waitcnt vmcnt(3)
    v_lshlrev_b32 v64, 16, v48
    v_and_b32 v65, 0xffff0000, v48
    v_lshlrev_b32 v66, 16, v49
    v_and_b32 v67, 0xffff0000, v49
    v_lshlrev_b32 v68, 16, v50
    v_and_b32 v69, 0xffff0000, v50
    v_lshlrev_b32 v70, 16, v51
    v_and_b32 v71, 0xffff0000, v51
    v_lshlrev_b32 v72, 16, v52
    v_and_b32 v73, 0xffff0000, v52
    v_lshlrev_b32 v74, 16, v53
    v_and_b32 v75, 0xffff0000, v53
    v_lshlrev_b32 v76, 16, v54
    v_and_b32 v77, 0xffff0000, v54
    v_lshlrev_b32 v78, 16, v55
    v_and_b32 v79, 0xffff0000, v55
    v_lshlrev_b32 v80, 16, v56
    v_and_b32 v81, 0xffff0000, v56
    v_lshlrev_b32 v82, 16, v57
    v_and_b32 v83, 0xffff0000, v57
    v_lshlrev_b32 v84, 16, v58
    v_and_b32 v85, 0xffff0000, v58
    v_lshlrev_b32 v86, 16, v59
    v_and_b32 v87, 0xffff0000, v59
    buffer_load_dwordx4 v[24:27], v7, s[12:15], s11 offen offset:0 sc1
    buffer_load_dwordx4 v[28:31], v7, s[12:15], s11 offen offset:1024 sc1
    buffer_load_dwordx4 v[32:35], v7, s[12:15], s11 offen offset:2048 sc1
    s_waitcnt lgkmcnt(0)
    s_barrier
    ds_read_b128 a[148:151], v7 offset:18432
    ds_read_b128 a[152:155], v7 offset:19456
    ds_read_b128 a[156:159], v7 offset:20480
    ds_read_b128 a[160:163], v7 offset:21504
    ds_read_b128 a[164:167], v7 offset:22528
    ds_read_b128 a[168:171], v7 offset:23552
    ds_read_b128 a[172:175], v7 offset:24576
    ds_read_b128 a[176:179], v7 offset:25600
    ds_read_b128 a[180:183], v7 offset:26624
    s_waitcnt lgkmcnt(8)
    v_mfma_f32_32x32x16_bf16 v[64:79], a[36:39], a[148:151], v[64:79]
    s_waitcnt lgkmcnt(7)
    v_mfma_f32_32x32x16_bf16 v[64:79], a[40:43], a[152:155], v[64:79]
    s_waitcnt lgkmcnt(6)
    v_mfma_f32_32x32x16_bf16 v[64:79], a[44:47], a[156:159], v[64:79]
    s_waitcnt lgkmcnt(5)
    v_mfma_f32_32x32x16_bf16 v[64:79], a[48:51], a[160:163], v[64:79]
    s_waitcnt lgkmcnt(4)
    v_mfma_f32_32x32x16_bf16 v[64:79], a[52:55], a[164:167], v[64:79]
    s_waitcnt lgkmcnt(3)
    v_mfma_f32_32x32x16_bf16 v[64:79], a[56:59], a[168:171], v[64:79]
    s_waitcnt lgkmcnt(2)
    v_mfma_f32_32x32x16_bf16 v[64:79], a[60:63], a[172:175], v[64:79]
    s_waitcnt lgkmcnt(1)
    v_mfma_f32_32x32x16_bf16 v[64:79], a[64:67], a[176:179], v[64:79]
    s_waitcnt lgkmcnt(0)
    v_mfma_f32_32x32x16_bf16 v[64:79], a[68:71], a[180:183], v[64:79]
    s_cmp_eq_u32 s28, 3
    s_cbranch_scc0 L3_gz
    v_mfma_f32_32x32x16_bf16 v[80:95], a[108:111], a[148:151], v[80:95]
    v_mfma_f32_32x32x16_bf16 v[80:95], a[112:115], a[152:155], v[80:95]
    v_mfma_f32_32x32x16_bf16 v[80:95], a[116:119], a[156:159], v[80:95]
    v_mfma_f32_32x32x16_bf16 v[80:95], a[120:123], a[160:163], v[80:95]
    v_mfma_f32_32x32x16_bf16 v[80:95], a[124:127], a[164:167], v[80:95]
    v_mfma_f32_32x32x16_bf16 v[80:95], a[128:131], a[168:171], v[80:95]
    v_mfma_f32_32x32x16_bf16 v[80:95], a[132:135], a[172:175], v[80:95]
    v_mfma_f32_32x32x16_bf16 v[80:95], a[136:139], a[176:179], v[80:95]
    v_mfma_f32_32x32x16_bf16 v[80:95], a[140:143], a[180:183], v[80:95]
L3_gz:
    ds_read_b128 v[176:179], v3 offset:0
    ds_read_b128 v[180:183], v3 offset:4096
    ds_read_b32 v184, v5 offset:0
    ds_read_b128 v[188:191], v3 offset:27648
    ds_read_b128 v[192:195], v3 offset:31744
    ds_read_b32 v196, v5 offset:27648
    ds_read_b128 v[200:203], v4 offset:0
    ds_read_b128 v[204:207], v4 offset:4096
    ds_read_b32 v208, v6 offset:0
    ds_read_b128 v[212:215], v4 offset:27648
    ds_read_b128 v[216:219], v4 offset:31744
    ds_read_b32 v220, v6 offset:27648
    s_waitcnt lgkmcnt(6)
    v_pk_add_f16 v176, v176, v188
    v_pk_add_f16 v177, v177, v189
    v_pk_add_f16 v178, v178, v190
    v_pk_add_f16 v179, v179, v191
    v_pk_add_f16 v180, v180, v192
    v_pk_add_f16 v181, v181, v193
    v_pk_add_f16 v182, v182, v194
    v_pk_add_f16 v183, v183, v195
    v_pk_add_f16 v184, v184, v196
    s_waitcnt lgkmcnt(0)
    v_pk_add_f16 v200, v200, v212
    v_pk_add_f16 v201, v201, v213
    v_pk_add_f16 v202, v202, v214
    v_pk_add_f16 v203, v203, v215
    v_pk_add_f16 v204, v204, v216
    v_pk_add_f16 v205, v205, v217
    v_pk_add_f16 v206, v206, v218
    v_pk_add_f16 v207, v207, v219
    v_pk_add_f16 v208, v208, v220
    v_pk_add_f16 v176, v176, v200
    v_pk_add_f16 v177, v177, v201
    v_pk_add_f16 v178, v178, v202
    v_pk_add_f16 v179, v179, v203
    v_pk_add_f16 v180, v180, v204
    v_pk_add_f16 v181, v181, v205
    v_pk_add_f16 v182, v182, v206
    v_pk_add_f16 v183, v183, v207
    v_pk_add_f16 v184, v184, v208
    s_mov_b32 s57, 0x4000
L3_poll:
    s_waitcnt vmcnt(0)
    v_max3_u32 v12, v24, v28, v35
    v_cmp_eq_u32 vcc, -1, v12
    s_sub_u32 s57, s57, 1
    s_cbranch_vccz L3_got
    s_cbranch_scc1 L3_got
    buffer_load_dwordx4 v[24:27], v7, s[12:15], s11 offen offset:0 sc1
    buffer_load_dwordx4 v[28:31], v7, s[12:15], s11 offen offset:1024 sc1
    buffer_load_dwordx4 v[32:35], v7, s[12:15], s11 offen offset:2048 sc1
    s_branch L3_poll
L3_got:
    v_min_f32 v12, v22, v33
    v_sub_f32 v13, v12, v22
    v_sub_f32 v14, v12, v33
    v_exp_f32 v13, v13
    v_exp_f32 v14, v14
    s_nop 0
    v_mul_f32 v13, v13, v23
    v_mul_f32 v14, v14, v34
    v_add_f32 v12, v13, v14
    v_rcp_f32 v12, v12
    s_nop 0
    v_mul_f32 v13, v13, v12
    v_mul_f32 v14, v14, v12
    v_fma_mix_f32 v188, v176, v13, 0 op_sel_hi:[1,0,0]
    v_fma_mix_f32 v189, v176, v13, 0 op_sel:[1,0,0] op_sel_hi:[1,0,0]
    v_fma_mix_f32 v188, v24, v14, v188 op_sel_hi:[1,0,0]
    v_fma_mix_f32 v189, v24, v14, v189 op_sel:[1,0,0] op_sel_hi:[1,0,0]
    v_cvt_pk_bf16_f32 v176, v188, v189
    v_fma_mix_f32 v190, v177, v13, 0 op_sel_hi:[1,0,0]
    v_fma_mix_f32 v191, v177, v13, 0 op_sel:[1,0,0] op_sel_hi:[1,0,0]
    v_fma_mix_f32 v190, v25, v14, v190 op_sel_hi:[1,0,0]
    v_fma_mix_f32 v191, v25, v14, v191 op_sel:[1,0,0] op_sel_hi:[1,0,0]
    v_cvt_pk_bf16_f32 v177, v190, v191
    v_fma_mix_f32 v192, v178, v13, 0 op_sel_hi:[1,0,0]
    v_fma_mix_f32 v193, v178, v13, 0 op_sel:[1,0,0] op_sel_hi:[1,0,0]
    v_fma_mix_f32 v192, v26, v14, v192 op_sel_hi:[1,0,0]
    v_fma_mix_f32 v193, v26, v14, v193 op_sel:[1,0,0] op_sel_hi:[1,0,0]
    v_cvt_pk_bf16_f32 v178, v192, v193
    v_fma_mix_f32 v194, v179, v13, 0 op_sel_hi:[1,0,0]
    v_fma_mix_f32 v195, v179, v13, 0 op_sel:[1,0,0] op_sel_hi:[1,0,0]
    v_fma_mix_f32 v194, v27, v14, v194 op_sel_hi:[1,0,0]
    v_fma_mix_f32 v195, v27, v14, v195 op_sel:[1,0,0] op_sel_hi:[1,0,0]
    v_cvt_pk_bf16_f32 v179, v194, v195
    ds_write_b128 v2, v[176:179]
    v_fma_mix_f32 v196, v180, v13, 0 op_sel_hi:[1,0,0]
    v_fma_mix_f32 v197, v180, v13, 0 op_sel:[1,0,0] op_sel_hi:[1,0,0]
    v_fma_mix_f32 v196, v28, v14, v196 op_sel_hi:[1,0,0]
    v_fma_mix_f32 v197, v28, v14, v197 op_sel:[1,0,0] op_sel_hi:[1,0,0]
    v_cvt_pk_bf16_f32 v180, v196, v197
    v_fma_mix_f32 v198, v181, v13, 0 op_sel_hi:[1,0,0]
    v_fma_mix_f32 v199, v181, v13, 0 op_sel:[1,0,0] op_sel_hi:[1,0,0]
    v_fma_mix_f32 v198, v29, v14, v198 op_sel_hi:[1,0,0]
    v_fma_mix_f32 v199, v29, v14, v199 op_sel:[1,0,0] op_sel_hi:[1,0,0]
    v_cvt_pk_bf16_f32 v181, v198, v199
    v_fma_mix_f32 v200, v182, v13, 0 op_sel_hi:[1,0,0]
    v_fma_mix_f32 v201, v182, v13, 0 op_sel:[1,0,0] op_sel_hi:[1,0,0]
    v_fma_mix_f32 v200, v30, v14, v200 op_sel_hi:[1,0,0]
    v_fma_mix_f32 v201, v30, v14, v201 op_sel:[1,0,0] op_sel_hi:[1,0,0]
    v_cvt_pk_bf16_f32 v182, v200, v201
    v_fma_mix_f32 v202, v183, v13, 0 op_sel_hi:[1,0,0]
    v_fma_mix_f32 v203, v183, v13, 0 op_sel:[1,0,0] op_sel_hi:[1,0,0]
    v_fma_mix_f32 v202, v31, v14, v202 op_sel_hi:[1,0,0]
    v_fma_mix_f32 v203, v31, v14, v203 op_sel:[1,0,0] op_sel_hi:[1,0,0]
    v_cvt_pk_bf16_f32 v183, v202, v203
    ds_write_b128 v2, v[180:183] offset:4096
    v_fma_mix_f32 v204, v184, v13, 0 op_sel_hi:[1,0,0]
    v_fma_mix_f32 v205, v184, v13, 0 op_sel:[1,0,0] op_sel_hi:[1,0,0]
    v_fma_mix_f32 v204, v32, v14, v204 op_sel_hi:[1,0,0]
    v_fma_mix_f32 v205, v32, v14, v205 op_sel:[1,0,0] op_sel_hi:[1,0,0]
    v_cvt_pk_bf16_f32 v184, v204, v205
    ds_write_b32 v1, v184
    s_waitcnt lgkmcnt(0)
    s_barrier
    ds_read_b128 a[148:151], v7 offset:46080
    ds_read_b128 a[152:155], v7 offset:47104
    ds_read_b128 a[156:159], v7 offset:48128
    ds_read_b128 a[160:163], v7 offset:49152
    ds_read_b128 a[164:167], v7 offset:50176
    ds_read_b128 a[168:171], v7 offset:51200
    ds_read_b128 a[172:175], v7 offset:52224
    ds_read_b128 a[176:179], v7 offset:53248
    ds_read_b128 a[180:183], v7 offset:54272
    s_waitcnt lgkmcnt(8)
    v_mfma_f32_32x32x16_bf16 v[64:79], a[0:3], a[148:151], v[64:79]
    s_waitcnt lgkmcnt(7)
    v_mfma_f32_32x32x16_bf16 v[64:79], a[4:7], a[152:155], v[64:79]
    s_waitcnt lgkmcnt(6)
    v_mfma_f32_32x32x16_bf16 v[64:79], a[8:11], a[156:159], v[64:79]
    s_waitcnt lgkmcnt(5)
    v_mfma_f32_32x32x16_bf16 v[64:79], a[12:15], a[160:163], v[64:79]
    s_waitcnt lgkmcnt(4)
    v_mfma_f32_32x32x16_bf16 v[64:79], a[16:19], a[164:167], v[64:79]
    s_waitcnt lgkmcnt(3)
    v_mfma_f32_32x32x16_bf16 v[64:79], a[20:23], a[168:171], v[64:79]
    s_waitcnt lgkmcnt(2)
    v_mfma_f32_32x32x16_bf16 v[64:79], a[24:27], a[172:175], v[64:79]
    s_waitcnt lgkmcnt(1)
    v_mfma_f32_32x32x16_bf16 v[64:79], a[28:31], a[176:179], v[64:79]
    s_waitcnt lgkmcnt(0)
    v_mfma_f32_32x32x16_bf16 v[64:79], a[32:35], a[180:183], v[64:79]
    s_cmp_eq_u32 s28, 3
    s_cbranch_scc0 L3_go
    v_mfma_f32_32x32x16_bf16 v[80:95], a[72:75], a[148:151], v[80:95]
    v_mfma_f32_32x32x16_bf16 v[80:95], a[76:79], a[152:155], v[80:95]
    v_mfma_f32_32x32x16_bf16 v[80:95], a[80:83], a[156:159], v[80:95]
    v_mfma_f32_32x32x16_bf16 v[80:95], a[84:87], a[160:163], v[80:95]
    v_mfma_f32_32x32x16_bf16 v[80:95], a[88:91], a[164:167], v[80:95]
    v_mfma_f32_32x32x16_bf16 v[80:95], a[92:95], a[168:171], v[80:95]
    v_mfma_f32_32x32x16_bf16 v[80:95], a[96:99], a[172:175], v[80:95]
    v_mfma_f32_32x32x16_bf16 v[80:95], a[100:103], a[176:179], v[80:95]
    v_mfma_f32_32x32x16_bf16 v[80:95], a[104:107], a[180:183], v[80:95]
L3_go:
    s_nop 7
    s_nop 3
    v_cvt_pk_bf16_f32 v48, v64, v65
    v_cvt_pk_bf16_f32 v49, v66, v67
    v_cvt_pk_bf16_f32 v50, v68, v69
    v_cvt_pk_bf16_f32 v51, v70, v71
    buffer_store_dwordx4 v[48:51], v9, s[20:23], s40 offen
    v_cvt_pk_bf16_f32 v52, v72, v73
    v_cvt_pk_bf16_f32 v53, v74, v75
    v_cvt_pk_bf16_f32 v54, v76, v77
    v_cvt_pk_bf16_f32 v55, v78, v79
    buffer_store_dwordx4 v[52:55], v9, s[20:23], s40 offen offset:32
    s_cbranch_scc0 L3_fin
    v_cvt_pk_bf16_f32 v56, v80, v81
    v_cvt_pk_bf16_f32 v57, v82, v83
    v_cvt_pk_bf16_f32 v58, v84, v85
    v_cvt_pk_bf16_f32 v59, v86, v87
    buffer_store_dwordx4 v[56:59], v9, s[20:23], s40 offen offset:64
L3_fin:
L3_exit:
    s_endpgm
L3_rare0:
    v_max3_f32 v12, v32, v33, v34
    v_max3_f32 v12, v12, v35, v36
    v_max3_f32 v12, v12, v37, v38
    v_max3_f32 v12, v12, v39, v40
    v_max3_f32 v12, v12, v41, v42
    v_max3_f32 v12, v12, v43, v44
    v_max3_f32 v12, v12, v45, v46
    v_max_f32 v12, v12, v47
    v_mov_b32 v13, v12
    s_nop 1
    v_permlane32_swap_b32 v12, v13
    s_nop 1
    v_max_f32 v12, v12, v13
    v_add_f32 v12, 0x41000000, v12
    v_max_f32 v12, s44, v12
    v_exp_f32 v14, -v12
    v_pk_add_f32 v[64:65], v[64:65], v[12:13] op_sel_hi:[1,0] neg_lo:[0,1] neg_hi:[0,1]
    v_pk_add_f32 v[32:33], v[32:33], v[12:13] op_sel_hi:[1,0] neg_lo:[0,1] neg_hi:[0,1]
    v_pk_add_f32 v[66:67], v[66:67], v[12:13] op_sel_hi:[1,0] neg_lo:[0,1] neg_hi:[0,1]
    v_pk_add_f32 v[34:35], v[34:35], v[12:13] op_sel_hi:[1,0] neg_lo:[0,1] neg_hi:[0,1]
    v_pk_add_f32 v[68:69], v[68:69], v[12:13] op_sel_hi:[1,0] neg_lo:[0,1] neg_hi:[0,1]
    v_pk_add_f32 v[36:37], v[36:37], v[12:13] op_sel_hi:[1,0] neg_lo:[0,1] neg_hi:[0,1]
    v_pk_add_f32 v[70:71], v[70:71], v[12:13] op_sel_hi:[1,0] neg_lo:[0,1] neg_hi:[0,1]
    v_pk_add_f32 v[38:39], v[38:39], v[12:13] op_sel_hi:[1,0] neg_lo:[0,1] neg_hi:[0,1]
    v_pk_add_f32 v[72:73], v[72:73], v[12:13] op_sel_hi:[1,0] neg_lo:[0,1] neg_hi:[0,1]
    v_pk_add_f32 v[40:41], v[40:41], v[12:13] op_sel_hi:[1,0] neg_lo:[0,1] neg_hi:[0,1]
    v_pk_add_f32 v[74:75], v[74:75], v[12:13] op_sel_hi:[1,0] neg_lo:[0,1] neg_hi:[0,1]
    v_pk_add_f32 v[42:43], v[42:43], v[12:13] op_sel_hi:[1,0] neg_lo:[0,1] neg_hi:[0,1]
    v_pk_add_f32 v[76:77], v[76:77], v[12:13] op_sel_hi:[1,0] neg_lo:[0,1] neg_hi:[0,1]
    v_pk_add_f32 v[44:45], v[44:45], v[12:13] op_sel_hi:[1,0] neg_lo:[0,1] neg_hi:[0,1]
    v_pk_add_f32 v[78:79], v[78:79], v[12:13] op_sel_hi:[1,0] neg_lo:[0,1] neg_hi:[0,1]
    v_pk_add_f32 v[46:47], v[46:47], v[12:13] op_sel_hi:[1,0] neg_lo:[0,1] neg_hi:[0,1]
    s_cmp_lg_u32 s42, 0
    s_cbranch_scc1 L3_first0
    v_pk_mul_f32 v[96:97], v[96:97], v[14:15] op_sel_hi:[1,0]
    v_pk_mul_f32 v[98:99], v[98:99], v[14:15] op_sel_hi:[1,0]
    v_pk_mul_f32 v[100:101], v[100:101], v[14:15] op_sel_hi:[1,0]
    v_pk_mul_f32 v[102:103], v[102:103], v[14:15] op_sel_hi:[1,0]
    v_pk_mul_f32 v[104:105], v[104:105], v[14:15] op_sel_hi:[1,0]
    v_pk_mul_f32 v[106:107], v[106:107], v[14:15] op_sel_hi:[1,0]
    v_pk_mul_f32 v[108:109], v[108:109], v[14:15] op_sel_hi:[1,0]
    v_pk_mul_f32 v[110:111], v[110:111], v[14:15] op_sel_hi:[1,0]
    v_pk_mul_f32 v[112:113], v[112:113], v[14:15] op_sel_hi:[1,0]
    v_pk_mul_f32 v[114:115], v[114:115], v[14:15] op_sel_hi:[1,0]
    v_pk_mul_f32 v[116:117], v[116:117], v[14:15] op_sel_hi:[1,0]
    v_pk_mul_f32 v[118:119], v[118:119], v[14:15] op_sel_hi:[1,0]
    v_pk_mul_f32 v[120:121], v[120:121], v[14:15] op_sel_hi:[1,0]
    v_pk_mul_f32 v[122:123], v[122:123], v[14:15] op_sel_hi:[1,0]
    v_pk_mul_f32 v[124:125], v[124:125], v[14:15] op_sel_hi:[1,0]
    v_pk_mul_f32 v[126:127], v[126:127], v[14:15] op_sel_hi:[1,0]
    v_pk_mul_f32 v[128:129], v[128:129], v[14:15] op_sel_hi:[1,0]
    v_pk_mul_f32 v[130:131], v[130:131], v[14:15] op_sel_hi:[1,0]
    v_pk_mul_f32 v[132:133], v[132:133], v[14:15] op_sel_hi:[1,0]
    v_pk_mul_f32 v[134:135], v[134:135], v[14:15] op_sel_hi:[1,0]
    v_pk_mul_f32 v[136:137], v[136:137], v[14:15] op_sel_hi:[1,0]
    v_pk_mul_f32 v[138:139], v[138:139], v[14:15] op_sel_hi:[1,0]
    v_pk_mul_f32 v[140:141], v[140:141], v[14:15] op_sel_hi:[1,0]
    v_pk_mul_f32 v[142:143], v[142:143], v[14:15] op_sel_hi:[1,0]
    v_pk_mul_f32 v[144:145], v[144:145], v[14:15] op_sel_hi:[1,0]
    v_pk_mul_f32 v[146:147], v[146:147], v[14:15] op_sel_hi:[1,0]
    v_pk_mul_f32 v[148:149], v[148:149], v[14:15] op_sel_hi:[1,0]
    v_pk_mul_f32 v[150:151], v[150:151], v[14:15] op_sel_hi:[1,0]
    v_pk_mul_f32 v[152:153], v[152:153], v[14:15] op_sel_hi:[1,0]
    v_pk_mul_f32 v[154:155], v[154:155], v[14:15] op_sel_hi:[1,0]
    v_pk_mul_f32 v[156:157], v[156:157], v[14:15] op_sel_hi:[1,0]
    v_pk_mul_f32 v[158:159], v[158:159], v[14:15] op_sel_hi:[1,0]
    v_pk_mul_f32 v[160:161], v[160:161], v[14:15] op_sel_hi:[1,0]
    v_pk_mul_f32 v[162:163], v[162:163], v[14:15] op_sel_hi:[1,0]
    v_pk_mul_f32 v[164:165], v[164:165], v[14:15] op_sel_hi:[1,0]
    v_pk_mul_f32 v[166:167], v[166:167], v[14:15] op_sel_hi:[1,0]
    v_pk_mul_f32 v[168:169], v[168:169], v[14:15] op_sel_hi:[1,0]
    v_pk_mul_f32 v[170:171], v[170:171], v[14:15] op_sel_hi:[1,0]
    v_pk_mul_f32 v[172:173], v[172:173], v[14:15] op_sel_hi:[1,0]
    v_pk_mul_f32 v[174:175], v[174:175], v[14:15] op_sel_hi:[1,0]
L3_first0:
    s_mov_b32 s44, 0
    s_mov_b32 s42, 0
    v_exp_f32 v16, v32
    v_exp_f32 v17, v33
    v_exp_f32 v18, v34
    v_exp_f32 v19, v35
    v_cvt_pk_bf16_f32 v24, v16, v17
    v_exp_f32 v20, v36
    v_exp_f32 v21, v37
    v_cvt_pk_bf16_f32 v25, v18, v19
    v_exp_f32 v22, v38
    v_exp_f32 v23, v39
    v_cvt_pk_bf16_f32 v26, v20, v21
    v_exp_f32 v16, v40
    v_exp_f32 v17, v41
    v_cvt_pk_bf16_f32 v27, v22, v23
    v_exp_f32 v18, v42
    v_exp_f32 v19, v43
    v_cvt_pk_bf16_f32 v28, v16, v17
    v_exp_f32 v20, v44
    v_exp_f32 v21, v45
    v_cvt_pk_bf16_f32 v29, v18, v19
    v_exp_f32 v22, v46
    v_exp_f32 v23, v47
    v_cvt_pk_bf16_f32 v30, v20, v21
    s_nop 0
    v_cvt_pk_bf16_f32 v31, v22, v23
    s_nop 0
    s_branch L3_back0
L3_rare1:
    v_max3_f32 v12, v48, v49, v50
    v_max3_f32 v12, v12, v51, v52
    v_max3_f32 v12, v12, v53, v54
    v_max3_f32 v12, v12, v55, v56
    v_max3_f32 v12, v12, v57, v58
    v_max3_f32 v12, v12, v59, v60
    v_max3_f32 v12, v12, v61, v62
    v_max_f32 v12, v12, v63
    v_mov_b32 v13, v12
    s_nop 1
    v_permlane32_swap_b32 v12, v13
    s_nop 1
    v_max_f32 v12, v12, v13
    v_add_f32 v12, 0x41000000, v12
    v_max_f32 v12, s45, v12
    v_exp_f32 v14, -v12
    v_pk_add_f32 v[80:81], v[80:81], v[12:13] op_sel_hi:[1,0] neg_lo:[0,1] neg_hi:[0,1]
    v_pk_add_f32 v[48:49], v[48:49], v[12:13] op_sel_hi:[1,0] neg_lo:[0,1] neg_hi:[0,1]
    v_pk_add_f32 v[82:83], v[82:83], v[12:13] op_sel_hi:[1,0] neg_lo:[0,1] neg_hi:[0,1]
    v_pk_add_f32 v[50:51], v[50:51], v[12:13] op_sel_hi:[1,0] neg_lo:[0,1] neg_hi:[0,1]
    v_pk_add_f32 v[84:85], v[84:85], v[12:13] op_sel_hi:[1,0] neg_lo:[0,1] neg_hi:[0,1]
    v_pk_add_f32 v[52:53], v[52:53], v[12:13] op_sel_hi:[1,0] neg_lo:[0,1] neg_hi:[0,1]
    v_pk_add_f32 v[86:87], v[86:87], v[12:13] op_sel_hi:[1,0] neg_lo:[0,1] neg_hi:[0,1]
    v_pk_add_f32 v[54:55], v[54:55], v[12:13] op_sel_hi:[1,0] neg_lo:[0,1] neg_hi:[0,1]
    v_pk_add_f32 v[88:89], v[88:89], v[12:13] op_sel_hi:[1,0] neg_lo:[0,1] neg_hi:[0,1]
    v_pk_add_f32 v[56:57], v[56:57], v[12:13] op_sel_hi:[1,0] neg_lo:[0,1] neg_hi:[0,1]
    v_pk_add_f32 v[90:91], v[90:91], v[12:13] op_sel_hi:[1,0] neg_lo:[0,1] neg_hi:[0,1]
    v_pk_add_f32 v[58:59], v[58:59], v[12:13] op_sel_hi:[1,0] neg_lo:[0,1] neg_hi:[0,1]
    v_pk_add_f32 v[92:93], v[92:93], v[12:13] op_sel_hi:[1,0] neg_lo:[0,1] neg_hi:[0,1]
    v_pk_add_f32 v[60:61], v[60:61], v[12:13] op_sel_hi:[1,0] neg_lo:[0,1] neg_hi:[0,1]
    v_pk_add_f32 v[94:95], v[94:95], v[12:13] op_sel_hi:[1,0] neg_lo:[0,1] neg_hi:[0,1]
    v_pk_add_f32 v[62:63], v[62:63], v[12:13] op_sel_hi:[1,0] neg_lo:[0,1] neg_hi:[0,1]
    s_cmp_lg_u32 s43, 0
    s_cbranch_scc1 L3_first1
    v_pk_mul_f32 v[176:177], v[176:177], v[14:15] op_sel_hi:[1,0]
    v_pk_mul_f32 v[178:179], v[178:179], v[14:15] op_sel_hi:[1,0]
    v_pk_mul_f32 v[180:181], v[180:181], v[14:15] op_sel_hi:[1,0]
    v_pk_mul_f32 v[182:183], v[182:183], v[14:15] op_sel_hi:[1,0]
    v_pk_mul_f32 v[184:185], v[184:185], v[14:15] op_sel_hi:[1,0]
    v_pk_mul_f32 v[186:187], v[186:187], v[14:15] op_sel_hi:[1,0]
    v_pk_mul_f32 v[188:189], v[188:189], v[14:15] op_sel_hi:[1,0]
    v_pk_mul_f32 v[190:191], v[190:191], v[14:15] op_sel_hi:[1,0]
    v_pk_mul_f32 v[192:193], v[192:193], v[14:15] op_sel_hi:[1,0]
    v_pk_mul_f32 v[194:195], v[194:195], v[14:15] op_sel_hi:[1,0]
    v_pk_mul_f32 v[196:197], v[196:197], v[14:15] op_sel_hi:[1,0]
    v_pk_mul_f32 v[198:199], v[198:199], v[14:15] op_sel_hi:[1,0]
    v_pk_mul_f32 v[200:201], v[200:201], v[14:15] op_sel_hi:[1,0]
    v_pk_mul_f32 v[202:203], v[202:203], v[14:15] op_sel_hi:[1,0]
    v_pk_mul_f32 v[204:205], v[204:205], v[14:15] op_sel_hi:[1,0]
    v_pk_mul_f32 v[206:207], v[206:207], v[14:15] op_sel_hi:[1,0]
    v_pk_mul_f32 v[208:209], v[208:209], v[14:15] op_sel_hi:[1,0]
    v_pk_mul_f32 v[210:211], v[210:211], v[14:15] op_sel_hi:[1,0]
    v_pk_mul_f32 v[212:213], v[212:213], v[14:15] op_sel_hi:[1,0]
    v_pk_mul_f32 v[214:215], v[214:215], v[14:15] op_sel_hi:[1,0]
    v_pk_mul_f32 v[216:217], v[216:217], v[14:15] op_sel_hi:[1,0]
    v_pk_mul_f32 v[218:219], v[218:219], v[14:15] op_sel_hi:[1,0]
    v_pk_mul_f32 v[220:221], v[220:221], v[14:15] op_sel_hi:[1,0]
    v_pk_mul_f32 v[222:223], v[222:223], v[14:15] op_sel_hi:[1,0]
    v_pk_mul_f32 v[224:225], v[224:225], v[14:15] op_sel_hi:[1,0]
    v_pk_mul_f32 v[226:227], v[226:227], v[14:15] op_sel_hi:[1,0]
    v_pk_mul_f32 v[228:229], v[228:229], v[14:15] op_sel_hi:[1,0]
    v_pk_mul_f32 v[230:231], v[230:231], v[14:15] op_sel_hi:[1,0]
    v_pk_mul_f32 v[232:233], v[232:233], v[14:15] op_sel_hi:[1,0]
    v_pk_mul_f32 v[234:235], v[234:235], v[14:15] op_sel_hi:[1,0]
    v_pk_mul_f32 v[236:237], v[236:237], v[14:15] op_sel_hi:[1,0]
    v_pk_mul_f32 v[238:239], v[238:239], v[14:15] op_sel_hi:[1,0]
    v_pk_mul_f32 v[240:241], v[240:241], v[14:15] op_sel_hi:[1,0]
    v_pk_mul_f32 v[242:243], v[242:243], v[14:15] op_sel_hi:[1,0]
    v_pk_mul_f32 v[244:245], v[244:245], v[14:15] op_sel_hi:[1,0]
    v_pk_mul_f32 v[246:247], v[246:247], v[14:15] op_sel_hi:[1,0]
    v_pk_mul_f32 v[248:249], v[248:249], v[14:15] op_sel_hi:[1,0]
    v_pk_mul_f32 v[250:251], v[250:251], v[14:15] op_sel_hi:[1,0]
    v_pk_mul_f32 v[252:253], v[252:253], v[14:15] op_sel_hi:[1,0]
    v_pk_mul_f32 v[254:255], v[254:255], v[14:15] op_sel_hi:[1,0]
L3_first1:
    s_mov_b32 s45, 0
    s_mov_b32 s43, 0
    v_exp_f32 v16, v48
    v_exp_f32 v17, v49
    v_exp_f32 v18, v50
    v_exp_f32 v19, v51
    v_cvt_pk_bf16_f32 v24, v16, v17
    v_exp_f32 v20, v52
    v_exp_f32 v21, v53
    v_cvt_pk_bf16_f32 v25, v18, v19
    v_exp_f32 v22, v54
    v_exp_f32 v23, v55
    v_cvt_pk_bf16_f32 v26, v20, v21
    v_exp_f32 v16, v56
    v_exp_f32 v17, v57
    v_cvt_pk_bf16_f32 v27, v22, v23
    v_exp_f32 v18, v58
    v_exp_f32 v19, v59
    v_cvt_pk_bf16_f32 v28, v16, v17
    v_exp_f32 v20, v60
    v_exp_f32 v21, v61
    v_cvt_pk_bf16_f32 v29, v18, v19
    v_exp_f32 v22, v62
    v_exp_f32 v23, v63
    v_cvt_pk_bf16_f32 v30, v20, v21
    s_nop 0
    v_cvt_pk_bf16_f32 v31, v22, v23
    s_nop 0
    s_branch L3_back1
L3_chk:
    s_cmp_eq_u32 s61, 3
    s_cbranch_scc1 L3_chk2
    s_cmp_eq_u32 s61, 5
    s_cbranch_scc1 L3_chk1
    s_cmp_eq_u32 s61, 14
    s_cbranch_scc0 L3_chk0
    s_mov_b32 s61, 10
    s_lshl2_add_u32 s60, s2, s28
    s_mul_i32 s60, s60, 3072
    s_add_u32 s60, s60, 7050240
    v_mov_b32 v12, -1
    v_mov_b32 v13, -1
    v_mov_b32 v14, -1
    v_mov_b32 v15, -1
    buffer_store_dwordx4 v[12:15], v7, s[12:15], s60 offen offset:0 sc1
    buffer_store_dwordx4 v[12:15], v7, s[12:15], s60 offen offset:1024 sc1
    buffer_store_dwordx4 v[12:15], v7, s[12:15], s60 offen offset:2048 sc1
    s_mov_b32 exec_lo, 0xc0000003
    s_mov_b32 exec_hi, 0xc0000003
    buffer_store_dwordx4 a[228:231], v7, s[12:15], s41 offen offset:1024 sc1
    buffer_store_dwordx4 a[232:235], v7, s[12:15], s41 offen offset:2048 sc1
    buffer_store_dwordx2 a[236:237], v7, s[12:15], s54 offen sc1
    s_mov_b64 exec, -1
    s_branch L3_chkb
L3_chk0:
    s_mov_b32 s61, 5
    s_lshl_b32 s60, s28, 3
    s_add_u32 s60, s60, s63
    v_mov_b32 v10, s68
    v_mov_b32 v11, s69
    s_mov_b64 exec, 1
    buffer_store_dwordx2 v[10:11], off, s[12:15], s60 offset:128 sc1
    s_mov_b64 exec, -1
    s_branch L3_chkb
L3_chk1:
    s_mov_b32 s61, 3
    buffer_load_dwordx2 v[10:11], v9, s[12:15], s62 offen sc1
    s_branch L3_chkb
L3_chk2:
    s_mov_b32 s60, 0x4000
L3_chk3:
    v_cmp_ne_u64 vcc, s[68:69], v[10:11]
    s_sub_u32 s60, s60, 1
    s_cbranch_scc1 L3_chk4
    s_cbranch_vccz L3_chk4
    buffer_load_dwordx2 v[10:11], v9, s[12:15], s62 offen sc1
    s_waitcnt vmcnt(0)
    s_branch L3_chk3
L3_chk4:
    s_cmp_eq_u32 s28, 3
    s_cbranch_scc0 L3_chkb
    v_accvgpr_read_b32 v11, a255
    s_add_u32 s60, s46, 4598784
    s_mov_b32 m0, 152064
    s_nop 0
    buffer_load_dwordx4 v11, s[12:15], s60 offen sc1 lds
    s_add_u32 s60, s60, 7168
    buffer_load_dwordx4 v11, s[12:15], s60 offen offset:1024 sc1 lds
    s_mov_b32 m0, 154112
    s_nop 0
    buffer_load_dwordx4 v7, s[24:27], 0 offen lds
    buffer_load_dwordx4 v7, s[24:27], 0 offen offset:1024 lds
    s_branch L3_chkb
L1_wt:
    s_sub_u32 s29, s2, 250
    s_cmp_ge_u32 s29, 3
    s_cselect_b32 s33, 0, 2
    s_cselect_b32 s30, 3, 0
    s_sub_u32 s29, s29, s30
    s_lshl_b32 s29, s29, 2
    s_add_u32 s29, s29, s28
    s_and_b32 s31, s29, 1
    s_lshr_b32 s29, s29, 1
    v_and_b32 v3, 0x13, v1
    v_bfe_u32 v4, v1, 2, 1
    v_lshl_add_u32 v3, v4, 3, v3
    v_bfe_u32 v4, v1, 3, 1
    v_lshl_add_u32 v3, v4, 2, v3
    v_mul_u32_u24 v3, 288, v3
    v_lshl_add_u32 v3, v2, 4, v3
    s_mul_i32 s34, s28, 10240
    s_mul_i32 s36, s31, 18432
    s_add_u32 s36, s36, 41984
    v_add_u32 v6, s36, v3
    s_lshl_b32 s37, s31, 12
    s_cmp_ge_u32 s29, 5
    s_cselect_b32 s37, 0x40000000, s37
    s_cmp_eq_u32 s33, 0
    s_waitcnt lgkmcnt(0)
    s_cbranch_scc1 L1_w_v
    s_mov_b32 s56, s44
    s_and_b32 s57, s45, 0xffff
    s_mov_b32 s58, 41472
    s_mov_b32 s59, 0x00020000
    s_add_u32 s35, s34, 0
    s_add_u32 m0, s35, 41984
    s_nop 0
    buffer_load_dwordx4 v8, s[56:59], s35 offen offset:0 lds
    buffer_load_dwordx4 v8, s[56:59], s35 offen offset:1024 lds
    buffer_load_dwordx4 v8, s[56:59], s35 offen offset:2048 lds
    buffer_load_dwordx4 v8, s[56:59], s35 offen offset:3072 lds
    s_add_u32 s35, s34, 4096
    s_add_u32 m0, s35, 41984
    s_nop 0
    buffer_load_dwordx4 v8, s[56:59], s35 offen offset:0 lds
    buffer_load_dwordx4 v8, s[56:59], s35 offen offset:1024 lds
    buffer_load_dwordx4 v8, s[56:59], s35 offen offset:2048 lds
    buffer_load_dwordx4 v8, s[56:59], s35 offen offset:3072 lds
    s_add_u32 s35, s34, 8192
    s_add_u32 m0, s35, 41984
    s_nop 0
    buffer_load_dwordx4 v8, s[56:59], s35 offen offset:0 lds
    buffer_load_dwordx4 v8, s[56:59], s35 offen offset:1024 lds
    buffer_load_dwordx4 v8, s[56:59], s35 offen offset:2048 lds
    s_mov_b32 s16, s46
    s_and_b32 s17, s47, 0xffff
    s_mov_b32 s18, 41472
    s_mov_b32 s19, 0x00020000
    s_mul_i32 s30, s29, 9216
    buffer_load_dwordx4 v[56:59], v3, s[16:19], s30 offen offset:0
    buffer_load_dwordx4 v[60:63], v3, s[16:19], s30 offen offset:32
    buffer_load_dwordx4 v[64:67], v3, s[16:19], s30 offen offset:64
    buffer_load_dwordx4 v[68:71], v3, s[16:19], s30 offen offset:96
    buffer_load_dwordx4 v[72:75], v3, s[16:19], s30 offen offset:128
    buffer_load_dwordx4 v[76:79], v3, s[16:19], s30 offen offset:160
    buffer_load_dwordx4 v[80:83], v3, s[16:19], s30 offen offset:192
    buffer_load_dwordx4 v[84:87], v3, s[16:19], s30 offen offset:224
    buffer_load_dwordx4 v[88:91], v3, s[16:19], s30 offen offset:256
    s_mov_b32 s24, s8
    s_and_b32 s25, s9, 0xffff
    s_mov_b32 s26, 10212352
    s_mov_b32 s27, 0x00020000
    s_mov_b32 s64, s10
    s_and_b32 s65, s11, 0xffff
    s_mov_b32 s66, 256
    s_mov_b32 s67, 0x00020000
    s_mov_b32 s40, 0x3df6384f
    s_mov_b32 s30, 0x40000000
    v_mov_b32 v4, v6
    s_branch L1_w_sk
L1_w_g3:
    s_add_u32 s32, s30, 4096
    ds_read_b128 v[128:131], v4 offset:0
    ds_read_b128 v[132:135], v4 offset:32
    ds_read_b128 v[136:139], v4 offset:64
    ds_read_b128 v[140:143], v4 offset:96
    ds_read_b128 v[144:147], v4 offset:128
    ds_read_b128 v[148:151], v4 offset:160
    ds_read_b128 v[152:155], v4 offset:192
    ds_read_b128 v[156:159], v4 offset:224
    ds_read_b128 v[160:163], v4 offset:256
    ds_read_b128 v[164:167], v4 offset:9216
    ds_read_b128 v[168:171], v4 offset:9248
    ds_read_b128 v[172:175], v4 offset:9280
    s_waitcnt lgkmcnt(11)
    v_mfma_f32_32x32x16_bf16 v[96:111], v[128:131], v[56:59], 0
    ds_read_b128 v[176:179], v4 offset:9312
    s_waitcnt lgkmcnt(11)
    v_mfma_f32_32x32x16_bf16 v[96:111], v[132:135], v[60:63], v[96:111]
    ds_read_b128 v[180:183], v4 offset:9344
    s_waitcnt lgkmcnt(11)
    v_mfma_f32_32x32x16_bf16 v[96:111], v[136:139], v[64:67], v[96:111]
    ds_read_b128 v[184:187], v4 offset:9376
    s_waitcnt lgkmcnt(11)
    v_mfma_f32_32x32x16_bf16 v[96:111], v[140:143], v[68:71], v[96:111]
    ds_read_b128 v[188:191], v4 offset:9408
    s_waitcnt lgkmcnt(11)
    v_mfma_f32_32x32x16_bf16 v[96:111], v[144:147], v[72:75], v[96:111]
    ds_read_b128 v[192:195], v4 offset:9440
    s_waitcnt lgkmcnt(11)
    v_mfma_f32_32x32x16_bf16 v[96:111], v[148:151], v[76:79], v[96:111]
    ds_read_b128 v[196:199], v4 offset:9472
    s_waitcnt lgkmcnt(11)
    v_mfma_f32_32x32x16_bf16 v[96:111], v[152:155], v[80:83], v[96:111]
    ds_read_b128 v[200:203], v4 offset:18432
    s_waitcnt lgkmcnt(11)
    v_mfma_f32_32x32x16_bf16 v[96:111], v[156:159], v[84:87], v[96:111]
    ds_read_b128 v[204:207], v4 offset:18464
    s_waitcnt lgkmcnt(11)
    v_mfma_f32_32x32x16_bf16 v[96:111], v[160:163], v[88:91], v[96:111]
    ds_read_b128 v[208:211], v4 offset:18496
    s_waitcnt lgkmcnt(11)
    v_mfma_f32_32x32x16_bf16 v[112:127], v[164:167], v[56:59], 0
    ds_read_b128 v[212:215], v4 offset:18528
    s_waitcnt lgkmcnt(11)
    v_mfma_f32_32x32x16_bf16 v[112:127], v[168:171], v[60:63], v[112:127]
    ds_read_b128 v[216:219], v4 offset:18560
    s_waitcnt lgkmcnt(11)
    v_mfma_f32_32x32x16_bf16 v[112:127], v[172:175], v[64:67], v[112:127]
    ds_read_b128 v[220:223], v4 offset:18592
    v_mul_f32 v96, s40, v96
    v_mul_f32 v97, s40, v97
    v_mul_f32 v98, s40, v98
    v_mul_f32 v99, s40, v99
    s_waitcnt lgkmcnt(11)
    v_mfma_f32_32x32x16_bf16 v[112:127], v[176:179], v[68:71], v[112:127]
    ds_read_b128 v[224:227], v4 offset:18624
    v_mul_f32 v100, s40, v100
    v_mul_f32 v101, s40, v101
    v_mul_f32 v102, s40, v102
    v_mul_f32 v103, s40, v103
    s_waitcnt lgkmcnt(11)
    v_mfma_f32_32x32x16_bf16 v[112:127], v[180:183], v[72:75], v[112:127]
    ds_read_b128 v[228:231], v4 offset:18656
    v_cvt_pk_bf16_f32 v16, v96, v97
    v_cvt_pk_bf16_f32 v17, v98, v99
    v_cvt_pk_bf16_f32 v18, v100, v101
    v_cvt_pk_bf16_f32 v19, v102, v103
    s_waitcnt lgkmcnt(11)
    v_mfma_f32_32x32x16_bf16 v[112:127], v[184:187], v[76:79], v[112:127]
    ds_read_b128 v[232:235], v4 offset:18688
    buffer_store_dwordx4 v[16:19], v8, s[24:27], s30 offen offset:0 sc1
    v_mul_f32 v104, s40, v104
    v_mul_f32 v105, s40, v105
    v_mul_f32 v106, s40, v106
    s_waitcnt lgkmcnt(11)
    v_mfma_f32_32x32x16_bf16 v[112:127], v[188:191], v[80:83], v[112:127]
    v_mul_f32 v107, s40, v107
    v_mul_f32 v108, s40, v108
    v_mul_f32 v109, s40, v109
    v_mul_f32 v110, s40, v110
    s_waitcnt lgkmcnt(10)
    v_mfma_f32_32x32x16_bf16 v[112:127], v[192:195], v[84:87], v[112:127]
    v_mul_f32 v111, s40, v111
    v_cvt_pk_bf16_f32 v20, v104, v105
    v_cvt_pk_bf16_f32 v21, v106, v107
    v_cvt_pk_bf16_f32 v22, v108, v109
    s_waitcnt lgkmcnt(9)
    v_mfma_f32_32x32x16_bf16 v[112:127], v[196:199], v[88:91], v[112:127]
    v_cvt_pk_bf16_f32 v23, v110, v111
    buffer_store_dwordx4 v[20:23], v8, s[24:27], s30 offen offset:1024 sc1
    s_waitcnt lgkmcnt(8)
    v_mfma_f32_32x32x16_bf16 v[96:111], v[200:203], v[56:59], 0
    s_waitcnt lgkmcnt(7)
    v_mfma_f32_32x32x16_bf16 v[96:111], v[204:207], v[60:63], v[96:111]
    s_waitcnt lgkmcnt(6)
    v_mfma_f32_32x32x16_bf16 v[96:111], v[208:211], v[64:67], v[96:111]
    v_mul_f32 v112, s40, v112
    v_mul_f32 v113, s40, v113
    v_mul_f32 v114, s40, v114
    v_mul_f32 v115, s40, v115
    s_waitcnt lgkmcnt(5)
    v_mfma_f32_32x32x16_bf16 v[96:111], v[212:215], v[68:71], v[96:111]
    v_mul_f32 v116, s40, v116
    v_mul_f32 v117, s40, v117
    v_mul_f32 v118, s40, v118
    v_mul_f32 v119, s40, v119
    s_waitcnt lgkmcnt(4)
    v_mfma_f32_32x32x16_bf16 v[96:111], v[216:219], v[72:75], v[96:111]
    v_cvt_pk_bf16_f32 v24, v112, v113
    v_cvt_pk_bf16_f32 v25, v114, v115
    v_cvt_pk_bf16_f32 v26, v116, v117
    v_cvt_pk_bf16_f32 v27, v118, v119
    s_waitcnt lgkmcnt(3)
    v_mfma_f32_32x32x16_bf16 v[96:111], v[220:223], v[76:79], v[96:111]
    buffer_store_dwordx4 v[24:27], v8, s[24:27], s30 offen offset:2048 sc1
    v_mul_f32 v120, s40, v120
    v_mul_f32 v121, s40, v121
    v_mul_f32 v122, s40, v122
    s_waitcnt lgkmcnt(2)
    v_mfma_f32_32x32x16_bf16 v[96:111], v[224:227], v[80:83], v[96:111]
    v_mul_f32 v123, s40, v123
    v_mul_f32 v124, s40, v124
    v_mul_f32 v125, s40, v125
    v_mul_f32 v126, s40, v126
    s_waitcnt lgkmcnt(1)
    v_mfma_f32_32x32x16_bf16 v[96:111], v[228:231], v[84:87], v[96:111]
    v_mul_f32 v127, s40, v127
    v_cvt_pk_bf16_f32 v28, v120, v121
    v_cvt_pk_bf16_f32 v29, v122, v123
    v_cvt_pk_bf16_f32 v30, v124, v125
    s_waitcnt lgkmcnt(0)
    v_mfma_f32_32x32x16_bf16 v[96:111], v[232:235], v[88:91], v[96:111]
    v_cvt_pk_bf16_f32 v31, v126, v127
    buffer_store_dwordx4 v[28:31], v8, s[24:27], s30 offen offset:3072 sc1
    s_nop 7
    s_nop 4
    v_mul_f32 v96, s40, v96
    v_mul_f32 v97, s40, v97
    v_mul_f32 v98, s40, v98
    v_mul_f32 v99, s40, v99
    v_mul_f32 v100, s40, v100
    v_mul_f32 v101, s40, v101
    v_mul_f32 v102, s40, v102
    v_mul_f32 v103, s40, v103
    v_cvt_pk_bf16_f32 v32, v96, v97
    v_cvt_pk_bf16_f32 v33, v98, v99
    v_cvt_pk_bf16_f32 v34, v100, v101
    v_cvt_pk_bf16_f32 v35, v102, v103
    buffer_store_dwordx4 v[32:35], v8, s[24:27], s32 offen offset:0 sc1
    s_cmp_eq_u32 s33, 1
    s_cbranch_scc1 L1_w_end
L1_w_sk:
    s_cmp_eq_u32 s33, 0
    s_mov_b32 s33, 1
    s_cbranch_scc1 L1_w_dm
    s_mul_i32 s30, s29, 9216
    s_add_u32 s30, s30, 7004160
    s_add_u32 s30, s30, s37
    s_waitcnt vmcnt(0)
    s_barrier
    s_branch L1_w_g3
L1_w_end:
    s_mul_i32 s30, s28, 3072
    s_add_u32 s30, s30, 119808
    v_add_u32 v3, s30, v8
    buffer_load_dwordx2 v[242:243], off, s[64:67], 0 sc1
    v_mov_b32 v12, 0
    v_mov_b32 v13, 0
    v_mov_b32 v14, 0
    v_mov_b32 v15, 0
    ds_write_b128 v3, v[12:15] offset:0
    ds_write_b128 v3, v[12:15] offset:1024
    ds_write_b128 v3, v[12:15] offset:2048
    s_waitcnt vmcnt(0) lgkmcnt(0)
    s_mov_b32 s3, 0x4000
L1_tkw:
    v_readfirstlane_b32 s68, v242
    v_readfirstlane_b32 s69, v243
    s_cmp_lg_u32 s68, 0
    s_cbranch_scc1 L1_tkdw
    s_sub_u32 s3, s3, 1
    s_cbranch_scc1 L1_tkdw
    buffer_load_dwordx2 v[242:243], off, s[64:67], 0 sc1
    s_waitcnt vmcnt(0)
    s_branch L1_tkw
L1_tkdw:
    s_lshl_b32 s63, s2, 8
    s_add_u32 s63, s63, 10146816
    s_barrier
    s_cmp_eq_u32 s28, 0
    s_cbranch_scc0 L1_w_nf2
    v_mov_b32 v242, s68
    v_mov_b32 v243, s69
    s_mov_b64 exec, 1
    buffer_store_dwordx2 v[242:243], off, s[24:27], s63 sc1
    s_mov_b64 exec, -1
L1_w_nf2:
    s_and_b32 s3, s2, 1
    s_bfe_u32 s52, s2, 0x10001
    s_mul_i32 s57, s52, 63
    s_add_u32 s57, s57, s28
    v_lshl_add_u32 v18, v0, 2, s57
    v_min_u32 v18, 124, v18
    v_lshl_add_u32 v18, v18, 1, s3
    v_add_u32 v19, 232, v0
    v_min_u32 v19, 252, v19
    v_cmp_gt_u32 vcc, 16, v0
    s_xor_b32 s57, s2, 2
    s_mov_b32 s12, s8
    s_and_b32 s13, s9, 0xffff
    s_mov_b32 s14, 10212352
    s_mov_b32 s15, 0x00020000
    s_mov_b32 s60, 10146816
    v_cndmask_b32 v18, v19, v18, vcc
    v_writelane_b32 v18, s57, 16
    v_writelane_b32 v18, s2, 17
    v_lshlrev_b32 v18, 8, v18
    buffer_load_dwordx2 v[22:23], v18, s[12:15], s60 offen sc1
    s_branch L3_start
L1_w_v:
    s_mov_b32 s12, s54
    s_and_b32 s13, s55, 0xffff
    s_mov_b32 s14, 41472
    s_mov_b32 s15, 0x00020000
    s_add_u32 s35, s34, 0
    s_add_u32 m0, s35, 0
    s_nop 0
    buffer_load_dwordx4 v8, s[12:15], s35 offen offset:0 lds
    buffer_load_dwordx4 v8, s[12:15], s35 offen offset:1024 lds
    buffer_load_dwordx4 v8, s[12:15], s35 offen offset:2048 lds
    buffer_load_dwordx4 v8, s[12:15], s35 offen offset:3072 lds
    s_add_u32 s35, s34, 4096
    s_add_u32 m0, s35, 0
    s_nop 0
    buffer_load_dwordx4 v8, s[12:15], s35 offen offset:0 lds
    buffer_load_dwordx4 v8, s[12:15], s35 offen offset:1024 lds
    buffer_load_dwordx4 v8, s[12:15], s35 offen offset:2048 lds
    buffer_load_dwordx4 v8, s[12:15], s35 offen offset:3072 lds
    s_add_u32 s35, s34, 8192
    s_add_u32 m0, s35, 0
    s_nop 0
    buffer_load_dwordx4 v8, s[12:15], s35 offen offset:0 lds
    buffer_load_dwordx4 v8, s[12:15], s35 offen offset:1024 lds
    buffer_load_dwordx4 v8, s[12:15], s35 offen offset:2048 lds
    s_mov_b32 s56, s50
    s_and_b32 s57, s51, 0xffff
    s_mov_b32 s58, 41472
    s_mov_b32 s59, 0x00020000
    s_add_u32 s35, s34, 0
    s_add_u32 m0, s35, 41984
    s_nop 0
    buffer_load_dwordx4 v8, s[56:59], s35 offen offset:0 lds
    buffer_load_dwordx4 v8, s[56:59], s35 offen offset:1024 lds
    buffer_load_dwordx4 v8, s[56:59], s35 offen offset:2048 lds
    buffer_load_dwordx4 v8, s[56:59], s35 offen offset:3072 lds
    s_add_u32 s35, s34, 4096
    s_add_u32 m0, s35, 41984
    s_nop 0
    buffer_load_dwordx4 v8, s[56:59], s35 offen offset:0 lds
    buffer_load_dwordx4 v8, s[56:59], s35 offen offset:1024 lds
    buffer_load_dwordx4 v8, s[56:59], s35 offen offset:2048 lds
    buffer_load_dwordx4 v8, s[56:59], s35 offen offset:3072 lds
    s_add_u32 s35, s34, 8192
    s_add_u32 m0, s35, 41984
    s_nop 0
    buffer_load_dwordx4 v8, s[56:59], s35 offen offset:0 lds
    buffer_load_dwordx4 v8, s[56:59], s35 offen offset:1024 lds
    buffer_load_dwordx4 v8, s[56:59], s35 offen offset:2048 lds
    s_mov_b32 s60, s48
    s_and_b32 s61, s49, 0xffff
    s_mov_b32 s62, 41472
    s_mov_b32 s63, 0x00020000
    s_add_u32 s35, s34, 0
    s_add_u32 m0, s35, 83968
    s_nop 0
    buffer_load_dwordx4 v8, s[60:63], s35 offen offset:0 lds
    buffer_load_dwordx4 v8, s[60:63], s35 offen offset:1024 lds
    buffer_load_dwordx4 v8, s[60:63], s35 offen offset:2048 lds
    buffer_load_dwordx4 v8, s[60:63], s35 offen offset:3072 lds
    s_add_u32 s35, s34, 4096
    s_add_u32 m0, s35, 83968
    s_nop 0
    buffer_load_dwordx4 v8, s[60:63], s35 offen offset:0 lds
    buffer_load_dwordx4 v8, s[60:63], s35 offen offset:1024 lds
    buffer_load_dwordx4 v8, s[60:63], s35 offen offset:2048 lds
    buffer_load_dwordx4 v8, s[60:63], s35 offen offset:3072 lds
    s_add_u32 s35, s34, 8192
    s_add_u32 m0, s35, 83968
    s_nop 0
    buffer_load_dwordx4 v8, s[60:63], s35 offen offset:0 lds
    buffer_load_dwordx4 v8, s[60:63], s35 offen offset:1024 lds
    buffer_load_dwordx4 v8, s[60:63], s35 offen offset:2048 lds
    s_mov_b32 s24, s8
    s_and_b32 s25, s9, 0xffff
    s_mov_b32 s26, 10212352
    s_mov_b32 s27, 0x00020000
    s_mov_b32 s64, s10
    s_and_b32 s65, s11, 0xffff
    s_mov_b32 s66, 256
    s_mov_b32 s67, 0x00020000
    v_bfe_u32 v10, v0, 2, 2
    v_lshl_add_u32 v10, v2, 3, v10
    v_mul_u32_u24 v10, 288, v10
    v_bfe_u32 v11, v0, 4, 1
    v_lshl_add_u32 v10, v11, 5, v10
    v_and_b32 v11, 1, v0
    v_lshl_add_u32 v10, v11, 4, v10
    v_bfe_u32 v11, v0, 1, 1
    v_lshl_add_u32 v10, v11, 3, v10
    s_lshl_b32 s35, s29, 6
    v_add_u32 v10, s35, v10
    v_add_u32 v3, 41984, v3
    v_mul_u32_u24 v4, 288, v1
    v_lshl_add_u32 v4, v2, 4, v4
    s_add_u32 s35, s36, 41984
    v_add_u32 v4, s35, v4
    s_mov_b32 s40, 1.0
    s_mul_i32 s30, s29, 18432
    s_add_u32 s30, s30, 6912000
    s_add_u32 s30, s30, s37
    s_waitcnt vmcnt(0)
    s_barrier
    ds_read_b64_tr_b16 v[16:17], v10 offset:0
    ds_read_b64_tr_b16 v[18:19], v10 offset:1152
    ds_read_b64_tr_b16 v[20:21], v10 offset:4608
    ds_read_b64_tr_b16 v[22:23], v10 offset:5760
    ds_read_b64_tr_b16 v[24:25], v10 offset:9216
    ds_read_b64_tr_b16 v[26:27], v10 offset:10368
    ds_read_b64_tr_b16 v[28:29], v10 offset:13824
    ds_read_b64_tr_b16 v[30:31], v10 offset:14976
    ds_read_b64_tr_b16 v[32:33], v10 offset:18432
    ds_read_b64_tr_b16 v[34:35], v10 offset:19584
    ds_read_b64_tr_b16 v[36:37], v10 offset:23040
    ds_read_b64_tr_b16 v[38:39], v10 offset:24192
    ds_read_b64_tr_b16 v[40:41], v10 offset:27648
    ds_read_b64_tr_b16 v[42:43], v10 offset:28800
    ds_read_b64_tr_b16 v[44:45], v10 offset:32256
    ds_read_b64_tr_b16 v[46:47], v10 offset:33408
    ds_read_b64_tr_b16 v[48:49], v10 offset:36864
    ds_read_b64_tr_b16 v[50:51], v10 offset:38016
    ds_read_b128 v[128:131], v3 offset:0
    ds_read_b128 v[132:135], v3 offset:32
    ds_read_b128 v[136:139], v3 offset:64
    ds_read_b128 v[140:143], v3 offset:96
    ds_read_b128 v[144:147], v3 offset:128
    ds_read_b128 v[148:151], v3 offset:160
    ds_read_b128 v[152:155], v3 offset:192
    ds_read_b128 v[156:159], v3 offset:224
    ds_read_b128 v[160:163], v3 offset:256
    s_waitcnt lgkmcnt(0)
    v_mfma_f32_32x32x16_bf16 v[96:111], v[128:131], v[16:19], 0
    ds_read_b128 v[164:167], v3 offset:9216
    v_mfma_f32_32x32x16_bf16 v[96:111], v[132:135], v[20:23], v[96:111]
    ds_read_b128 v[168:171], v3 offset:9248
    v_mfma_f32_32x32x16_bf16 v[96:111], v[136:139], v[24:27], v[96:111]
    ds_read_b128 v[172:175], v3 offset:9280
    v_mfma_f32_32x32x16_bf16 v[96:111], v[140:143], v[28:31], v[96:111]
    ds_read_b128 v[176:179], v3 offset:9312
    v_mfma_f32_32x32x16_bf16 v[96:111], v[144:147], v[32:35], v[96:111]
    ds_read_b128 v[180:183], v3 offset:9344
    v_mfma_f32_32x32x16_bf16 v[96:111], v[148:151], v[36:39], v[96:111]
    ds_read_b128 v[184:187], v3 offset:9376
    v_mfma_f32_32x32x16_bf16 v[96:111], v[152:155], v[40:43], v[96:111]
    ds_read_b128 v[188:191], v3 offset:9408
    v_mfma_f32_32x32x16_bf16 v[96:111], v[156:159], v[44:47], v[96:111]
    ds_read_b128 v[192:195], v3 offset:9440
    v_mfma_f32_32x32x16_bf16 v[96:111], v[160:163], v[48:51], v[96:111]
    ds_read_b128 v[196:199], v3 offset:9472
    s_waitcnt lgkmcnt(0)
    v_mfma_f32_32x32x16_bf16 v[112:127], v[164:167], v[16:19], 0
    ds_read_b128 v[128:131], v3 offset:18432
    v_mfma_f32_32x32x16_bf16 v[112:127], v[168:171], v[20:23], v[112:127]
    ds_read_b128 v[132:135], v3 offset:18464
    v_mfma_f32_32x32x16_bf16 v[112:127], v[172:175], v[24:27], v[112:127]
    ds_read_b128 v[136:139], v3 offset:18496
    v_mfma_f32_32x32x16_bf16 v[112:127], v[176:179], v[28:31], v[112:127]
    ds_read_b128 v[140:143], v3 offset:18528
    v_mfma_f32_32x32x16_bf16 v[112:127], v[180:183], v[32:35], v[112:127]
    ds_read_b128 v[144:147], v3 offset:18560
    v_mfma_f32_32x32x16_bf16 v[112:127], v[184:187], v[36:39], v[112:127]
    ds_read_b128 v[148:151], v3 offset:18592
    v_mfma_f32_32x32x16_bf16 v[112:127], v[188:191], v[40:43], v[112:127]
    ds_read_b128 v[152:155], v3 offset:18624
    v_mfma_f32_32x32x16_bf16 v[112:127], v[192:195], v[44:47], v[112:127]
    ds_read_b128 v[156:159], v3 offset:18656
    v_mfma_f32_32x32x16_bf16 v[112:127], v[196:199], v[48:51], v[112:127]
    ds_read_b128 v[160:163], v3 offset:18688
    v_cvt_pk_bf16_f32 v56, v96, v97
    v_cvt_pk_bf16_f32 v57, v98, v99
    v_cvt_pk_bf16_f32 v58, v100, v101
    v_cvt_pk_bf16_f32 v59, v102, v103
    v_cvt_pk_bf16_f32 v60, v104, v105
    v_cvt_pk_bf16_f32 v61, v106, v107
    v_cvt_pk_bf16_f32 v62, v108, v109
    v_cvt_pk_bf16_f32 v63, v110, v111
    s_waitcnt lgkmcnt(0)
    v_mfma_f32_32x32x16_bf16 v[96:111], v[128:131], v[16:19], 0
    ds_read_b128 v[164:167], v3 offset:27648
    v_mfma_f32_32x32x16_bf16 v[96:111], v[132:135], v[20:23], v[96:111]
    ds_read_b128 v[168:171], v3 offset:27680
    v_mfma_f32_32x32x16_bf16 v[96:111], v[136:139], v[24:27], v[96:111]
    ds_read_b128 v[172:175], v3 offset:27712
    v_mfma_f32_32x32x16_bf16 v[96:111], v[140:143], v[28:31], v[96:111]
    ds_read_b128 v[176:179], v3 offset:27744
    v_mfma_f32_32x32x16_bf16 v[96:111], v[144:147], v[32:35], v[96:111]
    ds_read_b128 v[180:183], v3 offset:27776
    v_mfma_f32_32x32x16_bf16 v[96:111], v[148:151], v[36:39], v[96:111]
    ds_read_b128 v[184:187], v3 offset:27808
    v_mfma_f32_32x32x16_bf16 v[96:111], v[152:155], v[40:43], v[96:111]
    ds_read_b128 v[188:191], v3 offset:27840
    v_mfma_f32_32x32x16_bf16 v[96:111], v[156:159], v[44:47], v[96:111]
    ds_read_b128 v[192:195], v3 offset:27872
    v_mfma_f32_32x32x16_bf16 v[96:111], v[160:163], v[48:51], v[96:111]
    ds_read_b128 v[196:199], v3 offset:27904
    v_cvt_pk_bf16_f32 v64, v112, v113
    v_cvt_pk_bf16_f32 v65, v114, v115
    v_cvt_pk_bf16_f32 v66, v116, v117
    v_cvt_pk_bf16_f32 v67, v118, v119
    v_cvt_pk_bf16_f32 v68, v120, v121
    v_cvt_pk_bf16_f32 v69, v122, v123
    v_cvt_pk_bf16_f32 v70, v124, v125
    v_cvt_pk_bf16_f32 v71, v126, v127
    s_waitcnt lgkmcnt(0)
    v_mfma_f32_32x32x16_bf16 v[112:127], v[164:167], v[16:19], 0
    ds_read_b128 v[128:131], v3 offset:36864
    v_mfma_f32_32x32x16_bf16 v[112:127], v[168:171], v[20:23], v[112:127]
    ds_read_b128 v[132:135], v3 offset:36896
    v_mfma_f32_32x32x16_bf16 v[112:127], v[172:175], v[24:27], v[112:127]
    ds_read_b128 v[136:139], v3 offset:36928
    v_mfma_f32_32x32x16_bf16 v[112:127], v[176:179], v[28:31], v[112:127]
    ds_read_b128 v[140:143], v3 offset:36960
    v_mfma_f32_32x32x16_bf16 v[112:127], v[180:183], v[32:35], v[112:127]
    ds_read_b128 v[144:147], v3 offset:36992
    v_mfma_f32_32x32x16_bf16 v[112:127], v[184:187], v[36:39], v[112:127]
    ds_read_b128 v[148:151], v3 offset:37024
    v_mfma_f32_32x32x16_bf16 v[112:127], v[188:191], v[40:43], v[112:127]
    ds_read_b128 v[152:155], v3 offset:37056
    v_mfma_f32_32x32x16_bf16 v[112:127], v[192:195], v[44:47], v[112:127]
    ds_read_b128 v[156:159], v3 offset:37088
    v_mfma_f32_32x32x16_bf16 v[112:127], v[196:199], v[48:51], v[112:127]
    ds_read_b128 v[160:163], v3 offset:37120
    v_cvt_pk_bf16_f32 v72, v96, v97
    v_cvt_pk_bf16_f32 v73, v98, v99
    v_cvt_pk_bf16_f32 v74, v100, v101
    v_cvt_pk_bf16_f32 v75, v102, v103
    v_cvt_pk_bf16_f32 v76, v104, v105
    v_cvt_pk_bf16_f32 v77, v106, v107
    v_cvt_pk_bf16_f32 v78, v108, v109
    v_cvt_pk_bf16_f32 v79, v110, v111
    s_waitcnt lgkmcnt(0)
    v_mfma_f32_32x32x16_bf16 v[96:111], v[128:131], v[16:19], 0
    v_mfma_f32_32x32x16_bf16 v[96:111], v[132:135], v[20:23], v[96:111]
    v_mfma_f32_32x32x16_bf16 v[96:111], v[136:139], v[24:27], v[96:111]
    v_mfma_f32_32x32x16_bf16 v[96:111], v[140:143], v[28:31], v[96:111]
    v_mfma_f32_32x32x16_bf16 v[96:111], v[144:147], v[32:35], v[96:111]
    v_mfma_f32_32x32x16_bf16 v[96:111], v[148:151], v[36:39], v[96:111]
    v_mfma_f32_32x32x16_bf16 v[96:111], v[152:155], v[40:43], v[96:111]
    v_mfma_f32_32x32x16_bf16 v[96:111], v[156:159], v[44:47], v[96:111]
    v_mfma_f32_32x32x16_bf16 v[96:111], v[160:163], v[48:51], v[96:111]
    v_cvt_pk_bf16_f32 v80, v112, v113
    v_cvt_pk_bf16_f32 v81, v114, v115
    v_cvt_pk_bf16_f32 v82, v116, v117
    v_cvt_pk_bf16_f32 v83, v118, v119
    v_cvt_pk_bf16_f32 v84, v120, v121
    v_cvt_pk_bf16_f32 v85, v122, v123
    v_cvt_pk_bf16_f32 v86, v124, v125
    v_cvt_pk_bf16_f32 v87, v126, v127
    s_nop 7
    s_nop 7
    v_cvt_pk_bf16_f32 v88, v96, v97
    v_cvt_pk_bf16_f32 v89, v98, v99
    v_cvt_pk_bf16_f32 v90, v100, v101
    v_cvt_pk_bf16_f32 v91, v102, v103
    s_barrier
    s_add_u32 s4, s54, 41472
    s_addc_u32 s5, s55, 0
    s_mov_b32 s12, s4
    s_and_b32 s13, s5, 0xffff
    s_mov_b32 s14, 41472
    s_mov_b32 s15, 0x00020000
    s_add_u32 s35, s34, 0
    s_add_u32 m0, s35, 0
    s_nop 0
    buffer_load_dwordx4 v8, s[12:15], s35 offen offset:0 lds
    buffer_load_dwordx4 v8, s[12:15], s35 offen offset:1024 lds
    buffer_load_dwordx4 v8, s[12:15], s35 offen offset:2048 lds
    buffer_load_dwordx4 v8, s[12:15], s35 offen offset:3072 lds
    s_add_u32 s35, s34, 4096
    s_add_u32 m0, s35, 0
    s_nop 0
    buffer_load_dwordx4 v8, s[12:15], s35 offen offset:0 lds
    buffer_load_dwordx4 v8, s[12:15], s35 offen offset:1024 lds
    buffer_load_dwordx4 v8, s[12:15], s35 offen offset:2048 lds
    buffer_load_dwordx4 v8, s[12:15], s35 offen offset:3072 lds
    s_add_u32 s35, s34, 8192
    s_add_u32 m0, s35, 0
    s_nop 0
    buffer_load_dwordx4 v8, s[12:15], s35 offen offset:0 lds
    buffer_load_dwordx4 v8, s[12:15], s35 offen offset:1024 lds
    buffer_load_dwordx4 v8, s[12:15], s35 offen offset:2048 lds
    s_mov_b32 s56, s52
    s_and_b32 s57, s53, 0xffff
    s_mov_b32 s58, 41472
    s_mov_b32 s59, 0x00020000
    s_add_u32 s35, s34, 0
    s_add_u32 m0, s35, 41984
    s_nop 0
    buffer_load_dwordx4 v8, s[56:59], s35 offen offset:0 lds
    buffer_load_dwordx4 v8, s[56:59], s35 offen offset:1024 lds
    buffer_load_dwordx4 v8, s[56:59], s35 offen offset:2048 lds
    buffer_load_dwordx4 v8, s[56:59], s35 offen offset:3072 lds
    s_add_u32 s35, s34, 4096
    s_add_u32 m0, s35, 41984
    s_nop 0
    buffer_load_dwordx4 v8, s[56:59], s35 offen offset:0 lds
    buffer_load_dwordx4 v8, s[56:59], s35 offen offset:1024 lds
    buffer_load_dwordx4 v8, s[56:59], s35 offen offset:2048 lds
    buffer_load_dwordx4 v8, s[56:59], s35 offen offset:3072 lds
    s_add_u32 s35, s34, 8192
    s_add_u32 m0, s35, 41984
    s_nop 0
    buffer_load_dwordx4 v8, s[56:59], s35 offen offset:0 lds
    buffer_load_dwordx4 v8, s[56:59], s35 offen offset:1024 lds
    buffer_load_dwordx4 v8, s[56:59], s35 offen offset:2048 lds
    s_branch L1_w_g3
L1_w_dm:
    s_add_u32 s30, s30, 9216
    v_mov_b32 v4, v6
    s_waitcnt vmcnt(0)
    s_barrier
    ds_read_b64_tr_b16 v[56:57], v10 offset:0
    ds_read_b64_tr_b16 v[58:59], v10 offset:1152
    ds_read_b64_tr_b16 v[60:61], v10 offset:4608
    ds_read_b64_tr_b16 v[62:63], v10 offset:5760
    ds_read_b64_tr_b16 v[64:65], v10 offset:9216
    ds_read_b64_tr_b16 v[66:67], v10 offset:10368
    ds_read_b64_tr_b16 v[68:69], v10 offset:13824
    ds_read_b64_tr_b16 v[70:71], v10 offset:14976
    ds_read_b64_tr_b16 v[72:73], v10 offset:18432
    ds_read_b64_tr_b16 v[74:75], v10 offset:19584
    ds_read_b64_tr_b16 v[76:77], v10 offset:23040
    ds_read_b64_tr_b16 v[78:79], v10 offset:24192
    ds_read_b64_tr_b16 v[80:81], v10 offset:27648
    ds_read_b64_tr_b16 v[82:83], v10 offset:28800
    ds_read_b64_tr_b16 v[84:85], v10 offset:32256
    ds_read_b64_tr_b16 v[86:87], v10 offset:33408
    ds_read_b64_tr_b16 v[88:89], v10 offset:36864
    ds_read_b64_tr_b16 v[90:91], v10 offset:38016
    s_branch L1_w_g3
L1_exit:
    s_endpgm
L1_last:
.section .rodata,"a"
.p2align 6
.amdhsa_kernel standalone__conformer_family_branchformer__speech_kernel
  .amdhsa_next_free_vgpr 512
  .amdhsa_next_free_sgpr 70
  .amdhsa_accum_offset 256
  .amdhsa_group_segment_fixed_size 0
  .amdhsa_kernarg_size 96
  .amdhsa_user_sgpr_count 2
  .amdhsa_user_sgpr_kernarg_segment_ptr 1
  .amdhsa_system_sgpr_workgroup_id_x 1
.end_amdhsa_kernel
```
